```python
import torch

def _softmax(x, axis=-1):
    return torch.softmax(x, dim=axis)
def _gelu(x):
    return torch.nn.functional.gelu(x, approximate="tanh")
def _silu(x):
    return torch.nn.functional.silu(x)
def _sigmoid(x):
    return torch.sigmoid(x)
def _layernorm(x, axis=-1, eps=1e-5):
    m = x.mean(dim=axis, keepdim=True)
    v = x.var(dim=axis, keepdim=True, unbiased=False)
    return (x - m) / torch.sqrt(v + eps)
def _scatter_add(tgt, idx, src, axis=0):
    return tgt.clone().index_add_(axis, idx, src)
def _segment_sum(src, seg, n):
    out = torch.zeros((n,) + src.shape[1:], dtype=src.dtype)
    return out.index_add_(0, seg, src)
def _pad(x, pw):
    flat = tuple(v for pair in reversed(pw) for v in pair)
    return torch.nn.functional.pad(x, flat)

kernel_name = 'sequential_preLN__sliding_local_dilated__mixer_token_mlp__prompt'

def setup_inputs():

    _w = (lambda a: (lambda t: t.to(torch.bfloat16) if t.is_floating_point() else t)(torch.as_tensor(a)))
    def _A_setup():
        B, S, D = 1, 2048, 512
        return {
            "x": _w((lambda *s: torch.randn(*s, dtype=torch.bfloat16) * 0.05)(B, S, D)),
            "wqkv": _w((lambda *s: torch.randn(*s, dtype=torch.bfloat16) * 0.05)(D, 3 * D)),
            "wo": _w((lambda *s: torch.randn(*s, dtype=torch.bfloat16) * 0.05)(D, D)),
        }
    _A_in = _A_setup()

    def _B_setup():
        B, S, D, F = 1, 2048, 512, 1792
        return {
            "x": _w((lambda *s: torch.randn(*s, dtype=torch.bfloat16) * 0.05)(B, S, D)),
            "w1": _w((lambda *s: torch.randn(*s, dtype=torch.bfloat16) * 1.6)(S, F) * (S ** -0.5)),
            "b1": _w((lambda *s: torch.randn(*s, dtype=torch.bfloat16) * 12.8)(F) * 0.02),
            "w2": _w((lambda *s: torch.randn(*s, dtype=torch.bfloat16) * 0.8)(F, S) * (F ** -0.5)),
            "b2": _w((lambda *s: torch.randn(*s, dtype=torch.bfloat16) * 12.8)(S) * 0.02),
        }
    _B_in = _B_setup()

    return {
        "A_x": _A_in["x"],
        "A_wqkv": _A_in["wqkv"],
        "A_wo": _A_in["wo"],
        "B_x": _B_in["x"],
        "B_w1": _B_in["w1"],
        "B_b1": _B_in["b1"],
        "B_w2": _B_in["w2"],
        "B_b2": _B_in["b2"],
    }

def reference(A_x, A_wqkv, A_wo, B_x, B_w1, B_b1, B_w2, B_b2):
    def _A_ref(x, wqkv, wo):
        B, S, D = x.shape
        H = 32; Dh = D // H
        W, dil = 8, 2
        qkv = (lambda x, *d: x.permute(*d))((x @ wqkv).reshape(B, S, 3, H, Dh), 2, 0, 3, 1, 4)
        q, k, v = qkv[0], qkv[1], qkv[2]
        scale = Dh ** -0.5
        pos = torch.arange(S)
        off = torch.arange(W) * dil
        idx = pos[:, None] - off[None, :]
        mask = idx >= 0
        idx_c = torch.where(mask, idx, 0).reshape(-1)
        kg = k[:, :, idx_c, :].reshape(B, H, S, W, Dh)
        vg = v[:, :, idx_c, :].reshape(B, H, S, W, Dh)
        logits = torch.einsum("bhsd,bhswd->bhsw", q, kg) * scale
        logits = torch.where(mask[None, None, :, :], logits, -1e9)
        attn = _softmax(logits, axis=-1)
        o = torch.einsum("bhsw,bhswd->bhsd", attn, vg)
        return (lambda x, *d: x.permute(*d))(o, 0, 2, 1, 3).reshape(B, S, D) @ wo

    def _B_ref(x, w1, b1, w2, b2):
        B, S, D = x.shape
        h = _layernorm(x, axis=-1)
        u = torch.einsum("bsd,sf->bdf", h, w1) + b1
        u = _gelu(u)
        y = torch.einsum("bdf,fs->bds", u, w2) + b2
        return (lambda x, *d: x.permute(*d))(y, 0, 2, 1)

    x = A_x
    h = x + _A_ref(_layernorm(x, axis=-1), A_wqkv, A_wo)
    h2 = h + _B_ref(_layernorm(h, axis=-1), B_w1, B_b1, B_w2, B_b2)
    return h2
```

```asm
; @launch grid=(256,1,1) block=(256,1,1) lds=163840
.amdgcn_target "amdgcn-amd-amdhsa--gfx950"
.text
.globl sequential_preLN__sliding_local_dilated__mixer_token_mlp__prompt_kernel
.p2align 8
.type sequential_preLN__sliding_local_dilated__mixer_token_mlp__prompt_kernel,@function
sequential_preLN__sliding_local_dilated__mixer_token_mlp__prompt_kernel:
  s_cmp_ge_u32 s2, 256
  s_cbranch_scc1 L_end
  s_load_dwordx2 s[4:5], s[0:1], 0
  s_load_dwordx2 s[8:9], s[0:1], 8
  s_load_dwordx2 s[24:25], s[0:1], 80
  s_load_dwordx2 s[12:13], s[0:1], 16
  s_getpc_b64 s[36:37]
L_pc:
  v_and_b32 v1, 63, v0
  v_lshrrev_b32 v2, 6, v0
  s_bfe_u32 s3, s2, 0x40003
  v_lshl_add_u32 v1, v1, 2, v2
  s_lshl_b32 s3, s3, 7
  v_lshl_add_u32 v1, v1, 11, s3
  v_min_u32 v2, L_cold-L_pc, v1
  global_load_dword v5, v2, s[36:37]
  v_lshrrev_b32 v2, 6, v0
  v_and_b32 v6, 63, v0
  v_readfirstlane_b32 s3, v2
  v_and_b32 v7, 15, v0
  v_bfe_u32 v8, v0, 4, 2
  s_mov_b32 s6, 2097152
  s_mov_b32 s7, 0x20000
  s_mov_b32 s10, 1572864
  s_mov_b32 s11, 0x20000
  s_mov_b32 s14, 524288
  s_mov_b32 s15, 0x20000
  s_lshl_b32 s36, s3, 10
  s_lshl_b32 s44, s3, 12
  s_lshr_b32 s42, s2, 6
  s_and_b32 s37, s2, 7
  s_lshl_b32 s37, s37, 2
  s_add_u32 s37, s37, s42
  s_bfe_u32 s38, s2, 0x30003
  s_lshr_b32 s49, s37, 2
  s_lshl_b32 s49, s49, 8
  s_and_b32 s41, s37, 1
  s_lshl_b32 s41, s41, 7
  s_add_u32 s49, s49, s41
  s_bfe_u32 s41, s37, 0x10001
  s_add_u32 s49, s49, s41
  s_add_u32 s51, s37, s38
  s_and_b32 s51, s51, 0
  s_lshl_b32 s51, s51, 7
  v_lshrrev_b32 v1, 3, v6
  v_and_b32 v2, 7, v6
  s_lshl_b32 s41, s3, 4
  s_add_u32 s41, s41, s49
  v_lshl_add_u32 v33, v1, 1, s41
  v_lshlrev_b32 v33, 10, v33
  s_and_b32 s50, s3, 1
  s_lshl_b32 s50, s50, 2
  v_xor_b32 v3, v2, v8
  v_xor_b32 v4, s50, v3
  v_lshl_add_u32 v33, v4, 4, v33
  v_add_u32 v34, 62464, v33
  s_sub_u32 s41, s49, 16
  v_lshl_add_u32 v35, v1, 1, s41
  v_max_i32 v35, 0, v35
  v_lshlrev_b32 v35, 10, v35
  v_xor_b32 v4, 4, v3
  v_lshl_add_u32 v35, v4, 4, v35
  s_lshl_b32 s41, s3, 7
  s_xor_b32 s52, s41, s51
  s_xor_b32 s53, s52, 512
  s_lshl_b32 s41, s3, 3
  v_add_u32 v36, s41, v1
  v_mul_u32_u24 v36, 3072, v36
  v_and_b32 v4, 2, v1
  v_xor_b32 v4, v4, v2
  v_xor_b32 v4, s50, v4
  v_lshl_add_u32 v36, v4, 4, v36
  s_lshl_b32 s41, s38, 7
  v_add_u32 v36, s41, v36
  v_add_u32 v37, 97280, v36
  v_lshlrev_b32 v43, 18, v6
  s_lshr_b32 s54, s2, 3
  s_lshl2_add_u32 s54, s54, s3
  s_lshl2_add_u32 s55, s2, s3
  v_cmp_lt_u32 vcc, 31, v6
  s_mul_i32 s41, s55, 576
  s_add_u32 s41, s41, 196608
  v_min_u32 v39, 4, v6
  v_lshl_add_u32 v39, v39, 7, s41
  s_mul_i32 s41, s54, 5120
  s_add_u32 s41, s41, 131456
  v_min_u32 v3, 4, v7
  v_lshl_add_u32 v3, v3, 10, s41
  v_cndmask_b32 v39, v39, v3, vcc
  s_mul_i32 s41, s55, 768
  s_add_u32 s41, s41, 786432
  v_min_u32 v40, 5, v6
  v_lshl_add_u32 v40, v40, 7, s41
  s_mul_i32 s41, s54, 6144
  s_add_u32 s41, s41, 786816
  v_min_u32 v3, 5, v7
  v_lshl_add_u32 v3, v3, 10, s41
  v_cndmask_b32 v40, v40, v3, vcc
  s_lshl_b32 s41, s55, 9
  v_and_b32 v3, 3, v6
  v_lshl_add_u32 v38, v3, 7, s41
  s_lshl_b32 s41, s54, 12
  s_add_u32 s41, s41, 384
  v_lshl_add_u32 v3, v3, 10, s41
  v_cndmask_b32 v38, v38, v3, vcc
  s_and_b32 s41, s2, 7
  s_lshl_b32 s41, s41, 8
  s_add_u32 s42, s41, s54
  s_add_u32 s41, s42, s54
  s_sub_u32 s42, s42, 16
  s_cmp_lt_u32 s54, 16
  s_cselect_b32 s42, s42, s41
  v_bfe_u32 v3, v6, 3, 1
  v_add_u32 v3, s41, v3
  v_mov_b32 v4, s42
  v_cndmask_b32 v3, v3, v4, vcc
  v_lshlrev_b32 v3, 10, v3
  v_and_b32 v4, 7, v6
  v_med3_u32 v41, v4, 1, 3
  v_lshl_add_u32 v41, v41, 7, v3
  v_med3_u32 v42, v4, 4, 7
  v_lshl_add_u32 v42, v42, 7, v3
  s_mul_i32 s55, s51, 1536
  s_mov_b32 s46, 6819840
  s_getreg_b32 s56, hwreg(HW_REG_XCC_ID, 0, 4)
  s_waitcnt lgkmcnt(0)
  s_load_dword s46, s[24:25], s46
  buffer_load_dword v5, v39, s[8:11], 0 offen
  buffer_load_dword v5, v41, s[4:7], 0 offen
  s_add_u32 m0, s36, 24576
  s_nop 0
  buffer_load_dwordx4 v35, s[4:7], s52 offen offset:0 lds
  s_add_u32 m0, s44, 49152
  s_nop 0
  buffer_load_dwordx4 v33, s[4:7], s51 offen offset:0 lds
  buffer_load_dwordx4 v37, s[8:11], s55 offen offset:1024 lds
  buffer_load_dwordx4 v37, s[8:11], s55 offen offset:2048 lds
  buffer_load_dwordx4 v37, s[8:11], s55 offen offset:3072 lds
  s_add_u32 m0, s44, 32768
  s_nop 0
  buffer_load_dwordx4 v34, s[4:7], s51 offen offset:3072 lds
  buffer_load_dwordx4 v36, s[8:11], s55 offen offset:0 lds
  buffer_load_dwordx4 v36, s[8:11], s55 offen offset:1024 lds
  buffer_load_dwordx4 v36, s[8:11], s55 offen offset:2048 lds
  s_load_dwordx2 s[16:17], s[0:1], 32
  s_load_dwordx2 s[20:21], s[0:1], 48
  s_load_dwordx2 s[28:29], s[0:1], 64
  s_load_dwordx2 s[96:97], s[0:1], 48
  s_load_dwordx2 s[32:33], s[0:1], 40
  s_load_dwordx2 s[34:35], s[0:1], 56
  s_mov_b32 s22, 7340032
  s_mov_b32 s23, 0x20000
  s_mov_b32 s26, 8388608
  s_mov_b32 s27, 0x20000
  s_mov_b32 s30, 2097152
  s_mov_b32 s31, 0x20000
  s_cmp_lt_u32 s2, 224
  s_cselect_b32 s18, 7340032, 0
  s_cselect_b32 s98, 0, 7340032
  s_mov_b32 s19, 0x20000
  s_mov_b32 s99, 0x20000
  s_bfe_u32 s41, s2, 0x20001
  s_mul_i32 s40, s41, 7
  s_lshr_b32 s41, s2, 5
  s_add_u32 s40, s40, s41
  s_and_b32 s39, s37, 4
  s_and_b32 s41, s38, 3
  s_or_b32 s39, s39, s41
  s_mov_b32 s43, 0
  s_and_b32 s41, s38, 1
  s_lshr_b32 s48, s3, 1
  s_lshl1_add_u32 s48, s41, s48
  s_bfe_u32 s41, s2, 0x20003
  s_mul_i32 s41, s41, 1835008
  s_lshl_b32 s42, s3, 16
  s_add_u32 s41, s41, s42
  s_and_b32 s42, s2, 7
  s_lshl_b32 s42, s42, 9
  s_add_u32 s41, s41, s42
  v_lshrrev_b32 v3, 2, v6
  v_lshl_add_u32 v9, v3, 12, s41
  v_and_b32 v3, 3, v6
  v_lshl_add_u32 v9, v3, 7, v9
  s_and_b32 s62, s39, 6
  s_bfe_u32 s41, s39, 0x10001
  s_and_b32 s62, s39, 4
  s_or_b32 s62, s62, s41
  s_lshr_b32 s41, s40, 1
  s_andn2_b32 s41, 2, s41
  s_or_b32 s62, s62, s41
  s_and_b32 s41, s3, 1
  s_lshl1_add_u32 s61, s62, s41
  s_lshl_b32 s61, s61, 12
  s_lshr_b32 s57, s62, 2
  s_mul_i32 s57, s57, 917504
  s_and_b32 s41, s62, 1
  s_mul_i32 s41, s41, 458752
  s_sub_u32 s58, s57, s41
  s_add_u32 s57, s57, s41
  s_add_u32 s58, s58, 458752
  s_bfe_u32 s41, s62, 0x10001
  s_mul_i32 s41, s41, 3584
  s_sub_u32 s42, 3584, s41
  s_add_u32 s59, s57, s42
  s_add_u32 s60, s58, s42
  s_add_u32 s57, s57, s41
  s_add_u32 s58, s58, s41
  s_lshl_b32 s41, s37, 16
  s_lshl_b32 s62, s38, 11
  s_add_u32 s41, s41, s62
  s_lshl_b32 s62, s3, 9
  s_add_u32 s41, s41, s62
  s_mov_b32 s63, 32768
  v_and_b32 v1, 31, v6
  v_lshl_add_u32 v10, v1, 4, s41
  v_lshrrev_b32 v1, 5, v6
  v_lshl_add_u32 v10, v1, 14, v10
  s_lshl_b32 s41, s37, 2
  s_add_u32 s41, s41, s3
  s_lshl_b32 s41, s41, 11
  s_add_u32 s64, s41, 6291456
  s_lshl_b32 s62, s38, 8
  s_add_u32 s41, s64, s62
  v_lshl_add_u32 v11, v7, 4, s41
  s_lshr_b32 s65, s37, 2
  s_lshl_b32 s65, s65, 4
  s_lshr_b32 s41, s3, 1
  s_lshl_b32 s41, s41, 3
  s_add_u32 s65, s65, s41
  s_and_b32 s41, s37, 3
  s_lshl_b32 s41, s41, 1
  s_add_u32 s65, s65, s41
  s_and_b32 s41, s3, 1
  s_add_u32 s65, s65, s41
  s_and_b32 s41, s2, 7
  s_lshl_b32 s41, s41, 7
  s_add_u32 s41, s41, 6815744
  v_and_b32 v1, 31, v6
  s_xor_b32 s54, s51, 128
  s_mul_i32 s55, s54, 1536
  s_add_u32 m0, s44, 81920
  s_nop 0
  buffer_load_dwordx4 v33, s[4:7], s54 offen offset:0 lds
  v_lshl_add_u32 v44, v1, 2, s41
  s_lshr_b32 s62, s2, 3
  s_lshl_b32 s62, s62, 2
  s_add_u32 s41, s41, s62
  v_lshl_add_u32 v13, v0, 23, s41
  v_and_b32 v1, 7, v6
  v_and_b32 v2, 1, v8
  v_lshlrev_b32 v2, 2, v2
  v_xor_b32 v1, v1, v2
  v_lshrrev_b32 v2, 3, v6
  s_and_b32 s62, s3, 1
  s_lshl3_add_u32 s41, s48, s62
  s_mul_i32 s41, s41, 229376
  s_lshl_b32 s62, s40, 7
  s_add_u32 s41, s41, s62
  v_lshl_add_u32 v3, v1, 4, s41
  v_mul_u32_u24 v2, 7168, v2
  v_add_u32 v15, v2, v3
  v_add_u32 v16, 56320, v15
  v_add_u32 v17, 112640, v15
  v_add_u32 v18, 168960, v15
  v_lshrrev_b32 v1, 1, v8
  v_lshrrev_b32 v2, 2, v7
  v_lshl_add_u32 v1, v1, 2, v2
  v_lshlrev_b32 v1, 7, v1
  v_and_b32 v2, 1, v8
  v_lshl_add_u32 v1, v2, 5, v1
  v_and_b32 v2, 3, v7
  v_lshl_add_u32 v1, v2, 3, v1
  v_lshrrev_b32 v2, 3, v7
  v_lshl_add_u32 v1, v2, 6, v1
  s_lshr_b32 s41, s3, 1
  s_lshl_b32 s41, s41, 6
  v_xor_b32 v1, s41, v1
  v_add_u32 v19, s44, v1
  v_xor_b32 v20, 64, v19
  v_add_u32 v21, 65536, v19
  v_add_u32 v22, 65536, v20
  v_add_u32 v23, 131072, v19
  v_add_u32 v24, 131072, v20
  v_mov_b32 v190, 0x3f803f80
  v_mov_b32 v191, 0x3f803f80
  v_mov_b32 v192, 0x3f803f80
  v_mov_b32 v193, 0x3f803f80
  s_lshl_b32 s41, s3, 11
  v_lshl_add_u32 v1, v6, 4, s41
  ds_write_b128 v1, v[190:193] offset:16384
  ds_write_b128 v1, v[190:193] offset:17408
  v_lshrrev_b32 v1, 1, v7
  v_xor_b32 v1, v1, v8
  v_xor_b32 v1, s50, v1
  v_lshlrev_b32 v1, 4, v1
  v_and_b32 v2, 7, v7
  v_lshl_add_u32 v1, v2, 7, v1
  v_lshrrev_b32 v2, 3, v7
  v_lshl_add_u32 v45, v2, 12, v1
  v_add_u32 v45, 32768, v45
  v_xor_b32 v194, 64, v45
  v_add_u32 v195, 65536, v45
  v_add_u32 v196, 65536, v194
  v_lshl_add_u32 v197, v2, 13, v1
  v_xor_b32 v198, 64, v197
  v_lshrrev_b32 v1, 2, v7
  v_lshlrev_b32 v2, 12, v8
  v_lshl_add_u32 v2, v1, 7, v2
  v_and_b32 v1, 2, v1
  v_and_b32 v3, 1, v8
  v_lshl_add_u32 v1, v3, 2, v1
  v_bfe_u32 v3, v7, 1, 1
  s_lshl_b32 s41, s3, 1
  v_add_u32 v3, s41, v3
  v_xor_b32 v1, v1, v3
  v_lshl_add_u32 v2, v1, 4, v2
  v_and_b32 v1, 1, v7
  v_lshl_add_u32 v2, v1, 3, v2
  buffer_load_dwordx4 v37, s[8:11], s55 offen offset:1024 lds
  s_mul_i32 s41, s50, 4352
  s_add_u32 s41, s41, 32768
  v_add_u32 v199, s41, v2
  v_xor_b32 v200, 17408, v199
  v_add_u32 v201, 65536, v199
  v_add_u32 v202, 65536, v200
  v_and_b32 v1, 3, v7
  v_cmp_eq_u32 s[66:67], 1, v1
  v_cmp_eq_u32 s[68:69], 2, v1
  v_cmp_eq_u32 s[70:71], 3, v1
  v_lshlrev_b32 v1, 2, v8
  v_sub_u32 v1, v7, v1
  s_mov_b32 s62, 0xf149f2ca
  v_mov_b32 v4, s62
  s_cmp_lt_u32 s49, 16
  s_cselect_b32 s80, s62, 0
  v_cmp_le_i32 s[72:73], 0, v1
  v_subrev_u32 v2, 0, v1
  v_and_b32 v2, 8, v2
  v_cmp_eq_u32 vcc, 0, v2
  s_nop 1
  v_cndmask_b32 v204, v4, 0, vcc
  v_min_f32 v208, s80, v204
  v_cmp_le_i32 s[74:75], 1, v1
  v_subrev_u32 v2, 1, v1
  v_and_b32 v2, 8, v2
  v_cmp_eq_u32 vcc, 0, v2
  s_nop 1
  v_cndmask_b32 v205, v4, 0, vcc
  v_min_f32 v209, s80, v205
  v_cmp_le_i32 s[76:77], 2, v1
  v_subrev_u32 v2, 2, v1
  v_and_b32 v2, 8, v2
  v_cmp_eq_u32 vcc, 0, v2
  s_nop 1
  v_cndmask_b32 v206, v4, 0, vcc
  v_min_f32 v210, s80, v206
  v_cmp_le_i32 s[78:79], 3, v1
  v_subrev_u32 v2, 3, v1
  v_and_b32 v2, 8, v2
  v_cmp_eq_u32 vcc, 0, v2
  s_nop 1
  v_cndmask_b32 v207, v4, 0, vcc
  v_min_f32 v211, s80, v207
  v_mov_b32 v2, 0xffff
  v_mov_b32 v3, 0xffff0000
  v_cndmask_b32 v1, 0, v2, s[72:73]
  v_cndmask_b32 v4, 0, v3, s[74:75]
  v_or_b32 v212, v1, v4
  v_not_b32 v214, v212
  v_cndmask_b32 v1, 0, v2, s[76:77]
  v_cndmask_b32 v4, 0, v3, s[78:79]
  v_or_b32 v213, v1, v4
  v_not_b32 v215, v213
  s_lshl_b32 s41, s3, 2
  v_lshl_add_u32 v203, v7, 4, s41
  v_lshrrev_b32 v1, 2, v7
  v_mov_b32 v2, 1280
  v_lshl_add_u32 v2, v6, 2, v2
  v_cmp_eq_u32 vcc, v1, v8
  s_nop 1
  v_cndmask_b32 v203, v2, v203, vcc
  v_lshlrev_b32 v216, 4, v6
  v_lshlrev_b32 v217, 4, v7
  s_mul_i32 s41, s3, 1280
  s_add_u32 s41, s41, 18944
  v_lshl_add_u32 v218, v6, 2, s41
  v_lshl_add_u32 v219, v7, 2, s41
  v_add_u32 v219, 256, v219
  v_lshl_add_u32 v220, v7, 3, s41
  buffer_load_dwordx4 v37, s[8:11], s55 offen offset:2048 lds
  v_lshl_add_u32 v221, v8, 4, s41
  v_lshl_add_u32 v222, v6, 3, s41
  v_lshrrev_b32 v1, 3, v6
  v_lshlrev_b32 v223, 10, v1
  v_and_b32 v1, 7, v6
  v_lshlrev_b32 v2, 1, v8
  v_xor_b32 v1, v1, v2
  v_lshl_add_u32 v223, v1, 4, v223
  s_lshl_b32 s41, s3, 15
  s_lshl_b32 s42, s38, 7
  s_add_u32 s41, s41, s42
  v_add_u32 v223, s41, v223
  v_add_u32 v224, 7168, v223
  v_add_u32 v225, 14336, v223
  v_add_u32 v226, 21504, v223
  v_lshrrev_b32 v1, 1, v8
  v_and_b32 v2, 1, v8
  v_lshlrev_b32 v1, 4, v1
  v_lshl_add_u32 v1, v2, 2, v1
  v_lshrrev_b32 v3, 2, v7
  v_add_u32 v1, v1, v3
  v_lshlrev_b32 v1, 7, v1
  v_and_b32 v3, 3, v7
  v_lshl_add_u32 v1, v3, 3, v1
  v_lshrrev_b32 v3, 3, v7
  v_lshl_add_u32 v2, v2, 1, v3
  v_lshl_add_u32 v1, v2, 5, v1
  v_add_u32 v25, 32768, v1
  v_xor_b32 v30, 32, v25
  v_xor_b32 v31, 64, v25
  v_xor_b32 v32, 96, v25
  s_lshl_b32 s41, s50, 3
  s_lshr_b32 s42, s3, 1
  s_add_u32 s41, s41, s42
  s_lshl_b32 s42, s37, 6
  s_add_u32 s41, s41, s42
  s_lshl_b32 s41, s41, 10
  s_lshl_b32 s42, s38, 7
  s_add_u32 s41, s41, s42
  v_lshrrev_b32 v1, 3, v6
  v_lshl_add_u32 v227, v1, 11, s41
  v_and_b32 v1, 7, v6
  v_xor_b32 v1, v1, v8
  v_lshl_add_u32 v227, v1, 4, v227
  v_add_u32 v228, 15360, v227
  v_xor_b32 v228, 64, v228
  s_lshl_b32 s80, s3, 11
  buffer_load_dwordx4 v37, s[8:11], s55 offen offset:3072 lds
  s_add_u32 m0, s44, 65536
  s_nop 0
  buffer_load_dwordx4 v34, s[4:7], s54 offen offset:3072 lds
  buffer_load_dwordx4 v36, s[8:11], s55 offen offset:0 lds
  buffer_load_dwordx4 v36, s[8:11], s55 offen offset:1024 lds
  buffer_load_dwordx4 v36, s[8:11], s55 offen offset:2048 lds
  buffer_load_dword v5, v38, s[12:15], 0 offen
  buffer_load_dword v5, v40, s[8:11], 0 offen
  buffer_load_dword v5, v42, s[4:7], 0 offen
  s_waitcnt lgkmcnt(0)
  s_lshr_b32 s46, s46, 4
  s_mul_i32 s46, s46, 0x9e3779b1
  s_add_u32 s46, s46, 0x7f4a7c15
  s_lshl_b32 s46, s46, 4
  s_or_b32 s46, s46, s56
  v_mov_b32 v14, s46
  s_lshr_b32 s41, s46, 4
  s_mov_b32 s81, 0x40004000
  v_and_b32 v1, 3, v6
  v_mul_u32_u24 v1, 0x47, v1
  v_add_u32 v1, s41, v1
  v_and_b32 v1, 0xff, v1
  v_lshl_or_b32 v1, v1, 15, v1
  v_lshlrev_b32 v26, 14, v1
  v_and_b32 v26, s81, v26
  v_lshlrev_b32 v27, 12, v1
  v_and_b32 v27, s81, v27
  v_lshlrev_b32 v28, 10, v1
  v_and_b32 v28, s81, v28
  v_lshlrev_b32 v29, 8, v1
  v_and_b32 v29, s81, v29
  s_min_u32 s41, s40, 27
  s_lshl_b32 s41, s41, 7
  v_mov_b32 v3, s41
  s_lshl_b32 s41, s37, 7
  v_mov_b32 v4, s41
  s_cmp_ge_u32 s3, 2
  s_waitcnt vmcnt(11)
  s_barrier
  s_cbranch_scc1 L_loopB
  ds_read_b64_tr_b16 v[86:87], v199 offset:0
  ds_read_b64_tr_b16 v[88:89], v199 offset:512
  ds_read_b64_tr_b16 v[90:91], v199 offset:1024
  ds_read_b64_tr_b16 v[92:93], v199 offset:1536
  ds_read_b64_tr_b16 v[94:95], v199 offset:2048
  ds_read_b64_tr_b16 v[96:97], v199 offset:2560
  ds_read_b128 v[46:49], v197 offset:16384
  ds_read_b128 v[50:53], v45 offset:16384
  ds_read_b128 v[54:57], v45 offset:24576
  ds_read_b128 v[58:61], v45 offset:3072
  ds_read_b128 v[62:65], v45 offset:11264
  s_waitcnt lgkmcnt(4)
  v_mfma_f32_16x16x32_bf16 v[170:173], v[190:193], v[46:49], 0
  ds_read_b64_tr_b16 v[98:99], v200 offset:0
  s_xor_b32 s54, s51, 256
  v_mfma_f32_16x16x32_bf16 v[110:113], v[86:89], v[46:49], 0
  ds_read_b64_tr_b16 v[100:101], v200 offset:512
  s_mul_i32 s55, s54, 1536
  v_mfma_f32_16x16x32_bf16 v[130:133], v[90:93], v[46:49], 0
  ds_read_b64_tr_b16 v[102:103], v200 offset:1024
  s_add_u32 m0, s44, 114688
  v_mfma_f32_16x16x32_bf16 v[150:153], v[46:49], v[94:97], 0
  ds_read_b64_tr_b16 v[104:105], v200 offset:1536
  s_waitcnt lgkmcnt(4)
  v_mfma_f32_16x16x32_bf16 v[174:177], v[190:193], v[50:53], 0
  ds_read_b64_tr_b16 v[106:107], v200 offset:2048
  buffer_load_dwordx4 v33, s[4:7], s54 offen offset:0 lds
  v_mfma_f32_16x16x32_bf16 v[114:117], v[86:89], v[50:53], 0
  ds_read_b64_tr_b16 v[108:109], v200 offset:2560
  v_mfma_f32_16x16x32_bf16 v[134:137], v[90:93], v[50:53], 0
  ds_read_b128 v[66:69], v198 offset:16384
  v_mfma_f32_16x16x32_bf16 v[154:157], v[50:53], v[94:97], 0
  ds_read_b128 v[70:73], v194 offset:16384
  buffer_load_dwordx4 v37, s[8:11], s55 offen offset:1024 lds
  v_mfma_f32_16x16x32_bf16 v[178:181], v[190:193], v[54:57], 0
  ds_read_b128 v[74:77], v194 offset:24576
  v_mfma_f32_16x16x32_bf16 v[118:121], v[86:89], v[54:57], 0
  ds_read_b128 v[78:81], v194 offset:3072
  v_mfma_f32_16x16x32_bf16 v[138:141], v[90:93], v[54:57], 0
  ds_read_b128 v[82:85], v194 offset:11264
  buffer_load_dwordx4 v37, s[8:11], s55 offen offset:2048 lds
  v_mfma_f32_16x16x32_bf16 v[158:161], v[54:57], v[94:97], 0
  v_mfma_f32_16x16x32_bf16 v[182:185], v[190:193], v[58:61], 0
  v_mfma_f32_16x16x32_bf16 v[122:125], v[86:89], v[58:61], 0
  buffer_load_dwordx4 v37, s[8:11], s55 offen offset:3072 lds
  s_add_u32 m0, s44, 98304
  v_mfma_f32_16x16x32_bf16 v[142:145], v[90:93], v[58:61], 0
  v_mfma_f32_16x16x32_bf16 v[162:165], v[58:61], v[94:97], 0
  v_mfma_f32_16x16x32_bf16 v[186:189], v[190:193], v[62:65], 0
  buffer_load_dwordx4 v34, s[4:7], s54 offen offset:3072 lds
  v_mfma_f32_16x16x32_bf16 v[126:129], v[86:89], v[62:65], 0
  v_mfma_f32_16x16x32_bf16 v[146:149], v[90:93], v[62:65], 0
  v_mfma_f32_16x16x32_bf16 v[166:169], v[62:65], v[94:97], 0
  buffer_load_dwordx4 v36, s[8:11], s55 offen offset:0 lds
  s_waitcnt lgkmcnt(0)
  s_waitcnt vmcnt(9)
  s_barrier
  v_mfma_f32_16x16x32_bf16 v[110:113], v[98:101], v[66:69], v[110:113]
  ds_read_b64_tr_b16 v[86:87], v199 offset:32768
  v_mfma_f32_16x16x32_bf16 v[130:133], v[102:105], v[66:69], v[130:133]
  ds_read_b64_tr_b16 v[88:89], v199 offset:33280
  v_mfma_f32_16x16x32_bf16 v[150:153], v[66:69], v[106:109], v[150:153]
  ds_read_b64_tr_b16 v[90:91], v199 offset:33792
  buffer_load_dwordx4 v36, s[8:11], s55 offen offset:1024 lds
  v_mfma_f32_16x16x32_bf16 v[114:117], v[98:101], v[70:73], v[114:117]
  ds_read_b64_tr_b16 v[92:93], v199 offset:34304
  v_mfma_f32_16x16x32_bf16 v[134:137], v[102:105], v[70:73], v[134:137]
  ds_read_b64_tr_b16 v[94:95], v199 offset:34816
  v_mfma_f32_16x16x32_bf16 v[154:157], v[70:73], v[106:109], v[154:157]
  ds_read_b64_tr_b16 v[96:97], v199 offset:35328
  buffer_load_dwordx4 v36, s[8:11], s55 offen offset:2048 lds
  v_mfma_f32_16x16x32_bf16 v[118:121], v[98:101], v[74:77], v[118:121]
  ds_read_b128 v[46:49], v197 offset:17408
  s_add_u32 m0, s36, 28672
  v_mfma_f32_16x16x32_bf16 v[138:141], v[102:105], v[74:77], v[138:141]
  ds_read_b128 v[50:53], v45 offset:49152
  v_mfma_f32_16x16x32_bf16 v[158:161], v[74:77], v[106:109], v[158:161]
  ds_read_b128 v[54:57], v45 offset:57344
  buffer_load_dwordx4 v35, s[4:7], s53 offen offset:0 lds
  v_mfma_f32_16x16x32_bf16 v[122:125], v[98:101], v[78:81], v[122:125]
  ds_read_b128 v[58:61], v45 offset:35840
  s_xor_b32 s54, s51, 384
  v_mfma_f32_16x16x32_bf16 v[142:145], v[102:105], v[78:81], v[142:145]
  ds_read_b128 v[62:65], v45 offset:44032
  s_mul_i32 s55, s54, 1536
  v_mfma_f32_16x16x32_bf16 v[162:165], v[78:81], v[106:109], v[162:165]
  s_add_u32 m0, s44, 147456
  s_nop 0
  buffer_load_dwordx4 v33, s[4:7], s54 offen offset:0 lds
  v_mfma_f32_16x16x32_bf16 v[126:129], v[98:101], v[82:85], v[126:129]
  v_mfma_f32_16x16x32_bf16 v[146:149], v[102:105], v[82:85], v[146:149]
  v_mfma_f32_16x16x32_bf16 v[166:169], v[82:85], v[106:109], v[166:169]
  buffer_load_dwordx4 v37, s[8:11], s55 offen offset:1024 lds
  s_waitcnt lgkmcnt(3)
  v_mfma_f32_16x16x32_bf16 v[170:173], v[190:193], v[46:49], v[170:173]
  ds_read_b64_tr_b16 v[98:99], v200 offset:32768
  v_mfma_f32_16x16x32_bf16 v[110:113], v[86:89], v[46:49], v[110:113]
  ds_read_b64_tr_b16 v[100:101], v200 offset:33280
  v_mfma_f32_16x16x32_bf16 v[130:133], v[90:93], v[46:49], v[130:133]
  ds_read_b64_tr_b16 v[102:103], v200 offset:33792
  buffer_load_dwordx4 v37, s[8:11], s55 offen offset:2048 lds
  v_mfma_f32_16x16x32_bf16 v[150:153], v[46:49], v[94:97], v[150:153]
  ds_read_b64_tr_b16 v[104:105], v200 offset:34304
  v_mfma_f32_16x16x32_bf16 v[174:177], v[190:193], v[50:53], v[174:177]
  ds_read_b64_tr_b16 v[106:107], v200 offset:34816
  v_mfma_f32_16x16x32_bf16 v[114:117], v[86:89], v[50:53], v[114:117]
  ds_read_b64_tr_b16 v[108:109], v200 offset:35328
  buffer_load_dwordx4 v37, s[8:11], s55 offen offset:3072 lds
  v_mfma_f32_16x16x32_bf16 v[134:137], v[90:93], v[50:53], v[134:137]
  ds_read_b128 v[66:69], v198 offset:17408
  s_add_u32 m0, s44, 131072
  v_mfma_f32_16x16x32_bf16 v[154:157], v[50:53], v[94:97], v[154:157]
  ds_read_b128 v[70:73], v194 offset:49152
  s_waitcnt lgkmcnt(8)
  v_mfma_f32_16x16x32_bf16 v[178:181], v[190:193], v[54:57], v[178:181]
  ds_read_b128 v[74:77], v194 offset:57344
  buffer_load_dwordx4 v34, s[4:7], s54 offen offset:3072 lds
  v_mfma_f32_16x16x32_bf16 v[118:121], v[86:89], v[54:57], v[118:121]
  ds_read_b128 v[78:81], v194 offset:35840
  v_mfma_f32_16x16x32_bf16 v[138:141], v[90:93], v[54:57], v[138:141]
  ds_read_b128 v[82:85], v194 offset:44032
  v_mfma_f32_16x16x32_bf16 v[158:161], v[54:57], v[94:97], v[158:161]
  buffer_load_dwordx4 v36, s[8:11], s55 offen offset:0 lds
  v_mfma_f32_16x16x32_bf16 v[182:185], v[190:193], v[58:61], v[182:185]
  v_mfma_f32_16x16x32_bf16 v[122:125], v[86:89], v[58:61], v[122:125]
  v_mfma_f32_16x16x32_bf16 v[142:145], v[90:93], v[58:61], v[142:145]
  buffer_load_dwordx4 v36, s[8:11], s55 offen offset:1024 lds
  v_mfma_f32_16x16x32_bf16 v[162:165], v[58:61], v[94:97], v[162:165]
  v_mfma_f32_16x16x32_bf16 v[186:189], v[190:193], v[62:65], v[186:189]
  v_mfma_f32_16x16x32_bf16 v[126:129], v[86:89], v[62:65], v[126:129]
  buffer_load_dwordx4 v36, s[8:11], s55 offen offset:2048 lds
  v_mfma_f32_16x16x32_bf16 v[146:149], v[90:93], v[62:65], v[146:149]
  v_mfma_f32_16x16x32_bf16 v[166:169], v[62:65], v[94:97], v[166:169]
  s_waitcnt lgkmcnt(0)
  s_waitcnt vmcnt(9)
  s_barrier
  v_mfma_f32_16x16x32_bf16 v[110:113], v[98:101], v[66:69], v[110:113]
  ds_read_b64_tr_b16 v[86:87], v201 offset:0
  s_xor_b32 s54, s51, 512
  v_mfma_f32_16x16x32_bf16 v[130:133], v[102:105], v[66:69], v[130:133]
  ds_read_b64_tr_b16 v[88:89], v201 offset:512
  s_mul_i32 s55, s54, 1536
  v_mfma_f32_16x16x32_bf16 v[150:153], v[66:69], v[106:109], v[150:153]
  ds_read_b64_tr_b16 v[90:91], v201 offset:1024
  s_add_u32 m0, s44, 49152
  v_mfma_f32_16x16x32_bf16 v[114:117], v[98:101], v[70:73], v[114:117]
  ds_read_b64_tr_b16 v[92:93], v201 offset:1536
  buffer_load_dwordx4 v33, s[4:7], s54 offen offset:0 lds
  v_mfma_f32_16x16x32_bf16 v[134:137], v[102:105], v[70:73], v[134:137]
  ds_read_b64_tr_b16 v[94:95], v201 offset:2048
  v_mfma_f32_16x16x32_bf16 v[154:157], v[70:73], v[106:109], v[154:157]
  ds_read_b64_tr_b16 v[96:97], v201 offset:2560
  v_mfma_f32_16x16x32_bf16 v[118:121], v[98:101], v[74:77], v[118:121]
  ds_read_b128 v[46:49], v197 offset:18432
  buffer_load_dwordx4 v37, s[8:11], s55 offen offset:1024 lds
  v_mfma_f32_16x16x32_bf16 v[138:141], v[102:105], v[74:77], v[138:141]
  ds_read_b128 v[50:53], v195 offset:16384
  v_mfma_f32_16x16x32_bf16 v[158:161], v[74:77], v[106:109], v[158:161]
  ds_read_b128 v[54:57], v195 offset:24576
  v_mfma_f32_16x16x32_bf16 v[122:125], v[98:101], v[78:81], v[122:125]
  ds_read_b128 v[58:61], v195 offset:3072
  buffer_load_dwordx4 v37, s[8:11], s55 offen offset:2048 lds
  v_mfma_f32_16x16x32_bf16 v[142:145], v[102:105], v[78:81], v[142:145]
  ds_read_b128 v[62:65], v195 offset:11264
  v_mfma_f32_16x16x32_bf16 v[162:165], v[78:81], v[106:109], v[162:165]
  v_mfma_f32_16x16x32_bf16 v[126:129], v[98:101], v[82:85], v[126:129]
  buffer_load_dwordx4 v37, s[8:11], s55 offen offset:3072 lds
  s_add_u32 m0, s44, 32768
  v_mfma_f32_16x16x32_bf16 v[146:149], v[102:105], v[82:85], v[146:149]
  v_mfma_f32_16x16x32_bf16 v[166:169], v[82:85], v[106:109], v[166:169]
  s_waitcnt lgkmcnt(3)
  v_mfma_f32_16x16x32_bf16 v[170:173], v[190:193], v[46:49], v[170:173]
  ds_read_b64_tr_b16 v[98:99], v202 offset:0
  buffer_load_dwordx4 v34, s[4:7], s54 offen offset:3072 lds
  v_mfma_f32_16x16x32_bf16 v[110:113], v[86:89], v[46:49], v[110:113]
  ds_read_b64_tr_b16 v[100:101], v202 offset:512
  v_mfma_f32_16x16x32_bf16 v[130:133], v[90:93], v[46:49], v[130:133]
  ds_read_b64_tr_b16 v[102:103], v202 offset:1024
  v_mfma_f32_16x16x32_bf16 v[150:153], v[46:49], v[94:97], v[150:153]
  ds_read_b64_tr_b16 v[104:105], v202 offset:1536
  buffer_load_dwordx4 v36, s[8:11], s55 offen offset:0 lds
  v_mfma_f32_16x16x32_bf16 v[174:177], v[190:193], v[50:53], v[174:177]
  ds_read_b64_tr_b16 v[106:107], v202 offset:2048
  v_mfma_f32_16x16x32_bf16 v[114:117], v[86:89], v[50:53], v[114:117]
  ds_read_b64_tr_b16 v[108:109], v202 offset:2560
  v_mfma_f32_16x16x32_bf16 v[134:137], v[90:93], v[50:53], v[134:137]
  ds_read_b128 v[66:69], v198 offset:18432
  buffer_load_dwordx4 v36, s[8:11], s55 offen offset:1024 lds
  v_mfma_f32_16x16x32_bf16 v[154:157], v[50:53], v[94:97], v[154:157]
  ds_read_b128 v[70:73], v196 offset:16384
  s_waitcnt lgkmcnt(8)
  v_mfma_f32_16x16x32_bf16 v[178:181], v[190:193], v[54:57], v[178:181]
  ds_read_b128 v[74:77], v196 offset:24576
  v_mfma_f32_16x16x32_bf16 v[118:121], v[86:89], v[54:57], v[118:121]
  ds_read_b128 v[78:81], v196 offset:3072
  buffer_load_dwordx4 v36, s[8:11], s55 offen offset:2048 lds
  v_mfma_f32_16x16x32_bf16 v[138:141], v[90:93], v[54:57], v[138:141]
  ds_read_b128 v[82:85], v196 offset:11264
  v_mfma_f32_16x16x32_bf16 v[158:161], v[54:57], v[94:97], v[158:161]
  v_mfma_f32_16x16x32_bf16 v[182:185], v[190:193], v[58:61], v[182:185]
  v_mfma_f32_16x16x32_bf16 v[122:125], v[86:89], v[58:61], v[122:125]
  v_mfma_f32_16x16x32_bf16 v[142:145], v[90:93], v[58:61], v[142:145]
  v_mfma_f32_16x16x32_bf16 v[162:165], v[58:61], v[94:97], v[162:165]
  v_mfma_f32_16x16x32_bf16 v[186:189], v[190:193], v[62:65], v[186:189]
  v_mfma_f32_16x16x32_bf16 v[126:129], v[86:89], v[62:65], v[126:129]
  v_mfma_f32_16x16x32_bf16 v[146:149], v[90:93], v[62:65], v[146:149]
  v_mfma_f32_16x16x32_bf16 v[166:169], v[62:65], v[94:97], v[166:169]
  s_waitcnt lgkmcnt(0)
  s_waitcnt vmcnt(8)
  s_barrier
  v_mfma_f32_16x16x32_bf16 v[110:113], v[98:101], v[66:69], v[110:113]
  ds_read_b64_tr_b16 v[86:87], v201 offset:32768
  s_xor_b32 s54, s51, 640
  v_mfma_f32_16x16x32_bf16 v[130:133], v[102:105], v[66:69], v[130:133]
  ds_read_b64_tr_b16 v[88:89], v201 offset:33280
  s_mul_i32 s55, s54, 1536
  v_mfma_f32_16x16x32_bf16 v[150:153], v[66:69], v[106:109], v[150:153]
  ds_read_b64_tr_b16 v[90:91], v201 offset:33792
  s_add_u32 m0, s44, 81920
  v_mfma_f32_16x16x32_bf16 v[114:117], v[98:101], v[70:73], v[114:117]
  ds_read_b64_tr_b16 v[92:93], v201 offset:34304
  buffer_load_dwordx4 v33, s[4:7], s54 offen offset:0 lds
  v_mfma_f32_16x16x32_bf16 v[134:137], v[102:105], v[70:73], v[134:137]
  ds_read_b64_tr_b16 v[94:95], v201 offset:34816
  v_mfma_f32_16x16x32_bf16 v[154:157], v[70:73], v[106:109], v[154:157]
  ds_read_b64_tr_b16 v[96:97], v201 offset:35328
  v_mfma_f32_16x16x32_bf16 v[118:121], v[98:101], v[74:77], v[118:121]
  ds_read_b128 v[46:49], v197 offset:19456
  buffer_load_dwordx4 v37, s[8:11], s55 offen offset:1024 lds
  v_mfma_f32_16x16x32_bf16 v[138:141], v[102:105], v[74:77], v[138:141]
  ds_read_b128 v[50:53], v195 offset:49152
  v_mfma_f32_16x16x32_bf16 v[158:161], v[74:77], v[106:109], v[158:161]
  ds_read_b128 v[54:57], v195 offset:57344
  v_mfma_f32_16x16x32_bf16 v[122:125], v[98:101], v[78:81], v[122:125]
  ds_read_b128 v[58:61], v195 offset:35840
  buffer_load_dwordx4 v37, s[8:11], s55 offen offset:2048 lds
  v_mfma_f32_16x16x32_bf16 v[142:145], v[102:105], v[78:81], v[142:145]
  ds_read_b128 v[62:65], v195 offset:44032
  v_mfma_f32_16x16x32_bf16 v[162:165], v[78:81], v[106:109], v[162:165]
  v_mfma_f32_16x16x32_bf16 v[126:129], v[98:101], v[82:85], v[126:129]
  buffer_load_dwordx4 v37, s[8:11], s55 offen offset:3072 lds
  s_add_u32 m0, s44, 65536
  v_mfma_f32_16x16x32_bf16 v[146:149], v[102:105], v[82:85], v[146:149]
  v_mfma_f32_16x16x32_bf16 v[166:169], v[82:85], v[106:109], v[166:169]
  s_waitcnt lgkmcnt(3)
  v_mfma_f32_16x16x32_bf16 v[170:173], v[190:193], v[46:49], v[170:173]
  ds_read_b64_tr_b16 v[98:99], v202 offset:32768
  buffer_load_dwordx4 v34, s[4:7], s54 offen offset:3072 lds
  v_mfma_f32_16x16x32_bf16 v[110:113], v[86:89], v[46:49], v[110:113]
  ds_read_b64_tr_b16 v[100:101], v202 offset:33280
  v_mfma_f32_16x16x32_bf16 v[130:133], v[90:93], v[46:49], v[130:133]
  ds_read_b64_tr_b16 v[102:103], v202 offset:33792
  v_mfma_f32_16x16x32_bf16 v[150:153], v[46:49], v[94:97], v[150:153]
  ds_read_b64_tr_b16 v[104:105], v202 offset:34304
  buffer_load_dwordx4 v36, s[8:11], s55 offen offset:0 lds
  v_mfma_f32_16x16x32_bf16 v[174:177], v[190:193], v[50:53], v[174:177]
  ds_read_b64_tr_b16 v[106:107], v202 offset:34816
  v_mfma_f32_16x16x32_bf16 v[114:117], v[86:89], v[50:53], v[114:117]
  ds_read_b64_tr_b16 v[108:109], v202 offset:35328
  v_mfma_f32_16x16x32_bf16 v[134:137], v[90:93], v[50:53], v[134:137]
  ds_read_b128 v[66:69], v198 offset:19456
  buffer_load_dwordx4 v36, s[8:11], s55 offen offset:1024 lds
  v_mfma_f32_16x16x32_bf16 v[154:157], v[50:53], v[94:97], v[154:157]
  ds_read_b128 v[70:73], v196 offset:49152
  s_waitcnt lgkmcnt(8)
  v_mfma_f32_16x16x32_bf16 v[178:181], v[190:193], v[54:57], v[178:181]
  ds_read_b128 v[74:77], v196 offset:57344
  v_mfma_f32_16x16x32_bf16 v[118:121], v[86:89], v[54:57], v[118:121]
  ds_read_b128 v[78:81], v196 offset:35840
  buffer_load_dwordx4 v36, s[8:11], s55 offen offset:2048 lds
  v_mfma_f32_16x16x32_bf16 v[138:141], v[90:93], v[54:57], v[138:141]
  ds_read_b128 v[82:85], v196 offset:44032
  v_mfma_f32_16x16x32_bf16 v[158:161], v[54:57], v[94:97], v[158:161]
  v_mfma_f32_16x16x32_bf16 v[182:185], v[190:193], v[58:61], v[182:185]
  buffer_store_dword v14, v13, s[24:27], 0 offen offset:0 sc1
  v_mfma_f32_16x16x32_bf16 v[122:125], v[86:89], v[58:61], v[122:125]
  v_mfma_f32_16x16x32_bf16 v[142:145], v[90:93], v[58:61], v[142:145]
  v_mfma_f32_16x16x32_bf16 v[162:165], v[58:61], v[94:97], v[162:165]
  v_mfma_f32_16x16x32_bf16 v[186:189], v[190:193], v[62:65], v[186:189]
  v_mfma_f32_16x16x32_bf16 v[126:129], v[86:89], v[62:65], v[126:129]
  v_mfma_f32_16x16x32_bf16 v[146:149], v[90:93], v[62:65], v[146:149]
  v_mfma_f32_16x16x32_bf16 v[166:169], v[62:65], v[94:97], v[166:169]
  s_waitcnt lgkmcnt(0)
  s_waitcnt vmcnt(9)
  s_barrier
  v_mfma_f32_16x16x32_bf16 v[110:113], v[98:101], v[66:69], v[110:113]
  ds_read_b64_tr_b16 v[86:87], v199 offset:0
  s_xor_b32 s54, s51, 768
  v_mfma_f32_16x16x32_bf16 v[130:133], v[102:105], v[66:69], v[130:133]
  ds_read_b64_tr_b16 v[88:89], v199 offset:512
  s_mul_i32 s55, s54, 1536
  v_mfma_f32_16x16x32_bf16 v[150:153], v[66:69], v[106:109], v[150:153]
  ds_read_b64_tr_b16 v[90:91], v199 offset:1024
  s_add_u32 m0, s44, 114688
  v_mfma_f32_16x16x32_bf16 v[114:117], v[98:101], v[70:73], v[114:117]
  ds_read_b64_tr_b16 v[92:93], v199 offset:1536
  buffer_load_dwordx4 v33, s[4:7], s54 offen offset:0 lds
  v_mfma_f32_16x16x32_bf16 v[134:137], v[102:105], v[70:73], v[134:137]
  ds_read_b64_tr_b16 v[94:95], v199 offset:2048
  v_mfma_f32_16x16x32_bf16 v[154:157], v[70:73], v[106:109], v[154:157]
  ds_read_b64_tr_b16 v[96:97], v199 offset:2560
  v_mfma_f32_16x16x32_bf16 v[118:121], v[98:101], v[74:77], v[118:121]
  ds_read_b128 v[46:49], v197 offset:20480
  buffer_load_dwordx4 v37, s[8:11], s55 offen offset:1024 lds
  v_mfma_f32_16x16x32_bf16 v[138:141], v[102:105], v[74:77], v[138:141]
  ds_read_b128 v[50:53], v45 offset:16384
  v_mfma_f32_16x16x32_bf16 v[158:161], v[74:77], v[106:109], v[158:161]
  ds_read_b128 v[54:57], v45 offset:24576
  v_mfma_f32_16x16x32_bf16 v[122:125], v[98:101], v[78:81], v[122:125]
  ds_read_b128 v[58:61], v45 offset:3072
  buffer_load_dwordx4 v37, s[8:11], s55 offen offset:2048 lds
  v_mfma_f32_16x16x32_bf16 v[142:145], v[102:105], v[78:81], v[142:145]
  ds_read_b128 v[62:65], v45 offset:11264
  v_mfma_f32_16x16x32_bf16 v[162:165], v[78:81], v[106:109], v[162:165]
  v_mfma_f32_16x16x32_bf16 v[126:129], v[98:101], v[82:85], v[126:129]
  buffer_load_dwordx4 v37, s[8:11], s55 offen offset:3072 lds
  s_add_u32 m0, s44, 98304
  v_mfma_f32_16x16x32_bf16 v[146:149], v[102:105], v[82:85], v[146:149]
  v_mfma_f32_16x16x32_bf16 v[166:169], v[82:85], v[106:109], v[166:169]
  s_waitcnt lgkmcnt(3)
  v_mfma_f32_16x16x32_bf16 v[170:173], v[190:193], v[46:49], v[170:173]
  ds_read_b64_tr_b16 v[98:99], v200 offset:0
  buffer_load_dwordx4 v34, s[4:7], s54 offen offset:3072 lds
  v_mfma_f32_16x16x32_bf16 v[110:113], v[86:89], v[46:49], v[110:113]
  ds_read_b64_tr_b16 v[100:101], v200 offset:512
  v_mfma_f32_16x16x32_bf16 v[130:133], v[90:93], v[46:49], v[130:133]
  ds_read_b64_tr_b16 v[102:103], v200 offset:1024
  v_mfma_f32_16x16x32_bf16 v[150:153], v[46:49], v[94:97], v[150:153]
  ds_read_b64_tr_b16 v[104:105], v200 offset:1536
  buffer_load_dwordx4 v36, s[8:11], s55 offen offset:0 lds
  v_mfma_f32_16x16x32_bf16 v[174:177], v[190:193], v[50:53], v[174:177]
  ds_read_b64_tr_b16 v[106:107], v200 offset:2048
  v_mfma_f32_16x16x32_bf16 v[114:117], v[86:89], v[50:53], v[114:117]
  ds_read_b64_tr_b16 v[108:109], v200 offset:2560
  v_mfma_f32_16x16x32_bf16 v[134:137], v[90:93], v[50:53], v[134:137]
  ds_read_b128 v[66:69], v198 offset:20480
  buffer_load_dwordx4 v36, s[8:11], s55 offen offset:1024 lds
  v_mfma_f32_16x16x32_bf16 v[154:157], v[50:53], v[94:97], v[154:157]
  ds_read_b128 v[70:73], v194 offset:16384
  s_waitcnt lgkmcnt(8)
  v_mfma_f32_16x16x32_bf16 v[178:181], v[190:193], v[54:57], v[178:181]
  ds_read_b128 v[74:77], v194 offset:24576
  v_mfma_f32_16x16x32_bf16 v[118:121], v[86:89], v[54:57], v[118:121]
  ds_read_b128 v[78:81], v194 offset:3072
  buffer_load_dwordx4 v36, s[8:11], s55 offen offset:2048 lds
  v_mfma_f32_16x16x32_bf16 v[138:141], v[90:93], v[54:57], v[138:141]
  ds_read_b128 v[82:85], v194 offset:11264
  v_mfma_f32_16x16x32_bf16 v[158:161], v[54:57], v[94:97], v[158:161]
  v_mfma_f32_16x16x32_bf16 v[182:185], v[190:193], v[58:61], v[182:185]
  v_mfma_f32_16x16x32_bf16 v[122:125], v[86:89], v[58:61], v[122:125]
  v_mfma_f32_16x16x32_bf16 v[142:145], v[90:93], v[58:61], v[142:145]
  v_mfma_f32_16x16x32_bf16 v[162:165], v[58:61], v[94:97], v[162:165]
  v_mfma_f32_16x16x32_bf16 v[186:189], v[190:193], v[62:65], v[186:189]
  v_mfma_f32_16x16x32_bf16 v[126:129], v[86:89], v[62:65], v[126:129]
  v_mfma_f32_16x16x32_bf16 v[146:149], v[90:93], v[62:65], v[146:149]
  v_mfma_f32_16x16x32_bf16 v[166:169], v[62:65], v[94:97], v[166:169]
  s_waitcnt lgkmcnt(0)
  s_waitcnt vmcnt(9)
  s_barrier
  v_mfma_f32_16x16x32_bf16 v[110:113], v[98:101], v[66:69], v[110:113]
  ds_read_b64_tr_b16 v[86:87], v199 offset:32768
  s_xor_b32 s54, s51, 896
  v_mfma_f32_16x16x32_bf16 v[130:133], v[102:105], v[66:69], v[130:133]
  ds_read_b64_tr_b16 v[88:89], v199 offset:33280
  s_mul_i32 s55, s54, 1536
  v_mfma_f32_16x16x32_bf16 v[150:153], v[66:69], v[106:109], v[150:153]
  ds_read_b64_tr_b16 v[90:91], v199 offset:33792
  s_add_u32 m0, s44, 147456
  v_mfma_f32_16x16x32_bf16 v[114:117], v[98:101], v[70:73], v[114:117]
  ds_read_b64_tr_b16 v[92:93], v199 offset:34304
  buffer_load_dwordx4 v33, s[4:7], s54 offen offset:0 lds
  v_mfma_f32_16x16x32_bf16 v[134:137], v[102:105], v[70:73], v[134:137]
  ds_read_b64_tr_b16 v[94:95], v199 offset:34816
  v_mfma_f32_16x16x32_bf16 v[154:157], v[70:73], v[106:109], v[154:157]
  ds_read_b64_tr_b16 v[96:97], v199 offset:35328
  v_mfma_f32_16x16x32_bf16 v[118:121], v[98:101], v[74:77], v[118:121]
  ds_read_b128 v[46:49], v197 offset:21504
  buffer_load_dwordx4 v37, s[8:11], s55 offen offset:1024 lds
  v_mfma_f32_16x16x32_bf16 v[138:141], v[102:105], v[74:77], v[138:141]
  ds_read_b128 v[50:53], v45 offset:49152
  v_mfma_f32_16x16x32_bf16 v[158:161], v[74:77], v[106:109], v[158:161]
  ds_read_b128 v[54:57], v45 offset:57344
  v_mfma_f32_16x16x32_bf16 v[122:125], v[98:101], v[78:81], v[122:125]
  ds_read_b128 v[58:61], v45 offset:35840
  buffer_load_dwordx4 v37, s[8:11], s55 offen offset:2048 lds
  v_mfma_f32_16x16x32_bf16 v[142:145], v[102:105], v[78:81], v[142:145]
  ds_read_b128 v[62:65], v45 offset:44032
  v_mfma_f32_16x16x32_bf16 v[162:165], v[78:81], v[106:109], v[162:165]
  v_mfma_f32_16x16x32_bf16 v[126:129], v[98:101], v[82:85], v[126:129]
  buffer_load_dwordx4 v37, s[8:11], s55 offen offset:3072 lds
  s_add_u32 m0, s44, 131072
  v_mfma_f32_16x16x32_bf16 v[146:149], v[102:105], v[82:85], v[146:149]
  v_mfma_f32_16x16x32_bf16 v[166:169], v[82:85], v[106:109], v[166:169]
  s_waitcnt lgkmcnt(3)
  v_mfma_f32_16x16x32_bf16 v[170:173], v[190:193], v[46:49], v[170:173]
  ds_read_b64_tr_b16 v[98:99], v200 offset:32768
  buffer_load_dwordx4 v34, s[4:7], s54 offen offset:3072 lds
  v_mfma_f32_16x16x32_bf16 v[110:113], v[86:89], v[46:49], v[110:113]
  ds_read_b64_tr_b16 v[100:101], v200 offset:33280
  v_mfma_f32_16x16x32_bf16 v[130:133], v[90:93], v[46:49], v[130:133]
  ds_read_b64_tr_b16 v[102:103], v200 offset:33792
  v_mfma_f32_16x16x32_bf16 v[150:153], v[46:49], v[94:97], v[150:153]
  ds_read_b64_tr_b16 v[104:105], v200 offset:34304
  buffer_load_dwordx4 v36, s[8:11], s55 offen offset:0 lds
  v_mfma_f32_16x16x32_bf16 v[174:177], v[190:193], v[50:53], v[174:177]
  ds_read_b64_tr_b16 v[106:107], v200 offset:34816
  v_mfma_f32_16x16x32_bf16 v[114:117], v[86:89], v[50:53], v[114:117]
  ds_read_b64_tr_b16 v[108:109], v200 offset:35328
  v_mfma_f32_16x16x32_bf16 v[134:137], v[90:93], v[50:53], v[134:137]
  ds_read_b128 v[66:69], v198 offset:21504
  buffer_load_dwordx4 v36, s[8:11], s55 offen offset:1024 lds
  v_mfma_f32_16x16x32_bf16 v[154:157], v[50:53], v[94:97], v[154:157]
  ds_read_b128 v[70:73], v194 offset:49152
  s_waitcnt lgkmcnt(8)
  v_mfma_f32_16x16x32_bf16 v[178:181], v[190:193], v[54:57], v[178:181]
  ds_read_b128 v[74:77], v194 offset:57344
  v_mfma_f32_16x16x32_bf16 v[118:121], v[86:89], v[54:57], v[118:121]
  ds_read_b128 v[78:81], v194 offset:35840
  buffer_load_dwordx4 v36, s[8:11], s55 offen offset:2048 lds
  v_mfma_f32_16x16x32_bf16 v[138:141], v[90:93], v[54:57], v[138:141]
  ds_read_b128 v[82:85], v194 offset:44032
  s_add_u32 m0, s44, 32768
  v_mfma_f32_16x16x32_bf16 v[158:161], v[54:57], v[94:97], v[158:161]
  s_mov_b32 s62, 0
  v_mfma_f32_16x16x32_bf16 v[182:185], v[190:193], v[58:61], v[182:185]
  buffer_load_dwordx4 v223, s[12:15], s62 offen offset:0 lds
  v_mfma_f32_16x16x32_bf16 v[122:125], v[86:89], v[58:61], v[122:125]
  v_mfma_f32_16x16x32_bf16 v[142:145], v[90:93], v[58:61], v[142:145]
  v_mfma_f32_16x16x32_bf16 v[162:165], v[58:61], v[94:97], v[162:165]
  buffer_load_dwordx4 v224, s[12:15], s62 offen offset:1024 lds
  v_mfma_f32_16x16x32_bf16 v[186:189], v[190:193], v[62:65], v[186:189]
  v_mfma_f32_16x16x32_bf16 v[126:129], v[86:89], v[62:65], v[126:129]
  v_mfma_f32_16x16x32_bf16 v[146:149], v[90:93], v[62:65], v[146:149]
  buffer_load_dwordx4 v225, s[12:15], s62 offen offset:2048 lds
  v_mfma_f32_16x16x32_bf16 v[166:169], v[62:65], v[94:97], v[166:169]
  s_waitcnt lgkmcnt(0)
  s_waitcnt vmcnt(11)
  s_barrier
  v_mfma_f32_16x16x32_bf16 v[110:113], v[98:101], v[66:69], v[110:113]
  ds_read_b64_tr_b16 v[86:87], v201 offset:0
  v_mfma_f32_16x16x32_bf16 v[130:133], v[102:105], v[66:69], v[130:133]
  ds_read_b64_tr_b16 v[88:89], v201 offset:512
  buffer_load_dwordx4 v226, s[12:15], s62 offen offset:3072 lds
  v_mfma_f32_16x16x32_bf16 v[150:153], v[66:69], v[106:109], v[150:153]
  ds_read_b64_tr_b16 v[90:91], v201 offset:1024
  s_add_u32 m0, s44, 49152
  v_mfma_f32_16x16x32_bf16 v[114:117], v[98:101], v[70:73], v[114:117]
  ds_read_b64_tr_b16 v[92:93], v201 offset:1536
  s_mov_b32 s62, 131072
  v_mfma_f32_16x16x32_bf16 v[134:137], v[102:105], v[70:73], v[134:137]
  ds_read_b64_tr_b16 v[94:95], v201 offset:2048
  buffer_load_dwordx4 v223, s[12:15], s62 offen offset:0 lds
  v_mfma_f32_16x16x32_bf16 v[154:157], v[70:73], v[106:109], v[154:157]
  ds_read_b64_tr_b16 v[96:97], v201 offset:2560
  v_mfma_f32_16x16x32_bf16 v[118:121], v[98:101], v[74:77], v[118:121]
  ds_read_b128 v[46:49], v197 offset:22528
  v_mfma_f32_16x16x32_bf16 v[138:141], v[102:105], v[74:77], v[138:141]
  ds_read_b128 v[50:53], v195 offset:16384
  buffer_load_dwordx4 v224, s[12:15], s62 offen offset:1024 lds
  v_mfma_f32_16x16x32_bf16 v[158:161], v[74:77], v[106:109], v[158:161]
  ds_read_b128 v[54:57], v195 offset:24576
  v_mfma_f32_16x16x32_bf16 v[122:125], v[98:101], v[78:81], v[122:125]
  ds_read_b128 v[58:61], v195 offset:3072
  v_mfma_f32_16x16x32_bf16 v[142:145], v[102:105], v[78:81], v[142:145]
  ds_read_b128 v[62:65], v195 offset:11264
  buffer_load_dwordx4 v225, s[12:15], s62 offen offset:2048 lds
  v_mfma_f32_16x16x32_bf16 v[162:165], v[78:81], v[106:109], v[162:165]
  v_mfma_f32_16x16x32_bf16 v[126:129], v[98:101], v[82:85], v[126:129]
  v_mfma_f32_16x16x32_bf16 v[146:149], v[102:105], v[82:85], v[146:149]
  buffer_load_dwordx4 v226, s[12:15], s62 offen offset:3072 lds
  s_add_u32 m0, s44, 65536
  v_mfma_f32_16x16x32_bf16 v[166:169], v[82:85], v[106:109], v[166:169]
  s_mov_b32 s62, 262144
  s_waitcnt lgkmcnt(3)
  v_mfma_f32_16x16x32_bf16 v[170:173], v[190:193], v[46:49], v[170:173]
  ds_read_b64_tr_b16 v[98:99], v202 offset:0
  v_mfma_f32_16x16x32_bf16 v[110:113], v[86:89], v[46:49], v[110:113]
  ds_read_b64_tr_b16 v[100:101], v202 offset:512
  buffer_load_dwordx4 v223, s[12:15], s62 offen offset:0 lds
  v_mfma_f32_16x16x32_bf16 v[130:133], v[90:93], v[46:49], v[130:133]
  ds_read_b64_tr_b16 v[102:103], v202 offset:1024
  v_mfma_f32_16x16x32_bf16 v[150:153], v[46:49], v[94:97], v[150:153]
  ds_read_b64_tr_b16 v[104:105], v202 offset:1536
  v_mfma_f32_16x16x32_bf16 v[174:177], v[190:193], v[50:53], v[174:177]
  ds_read_b64_tr_b16 v[106:107], v202 offset:2048
  buffer_load_dwordx4 v224, s[12:15], s62 offen offset:1024 lds
  v_mfma_f32_16x16x32_bf16 v[114:117], v[86:89], v[50:53], v[114:117]
  ds_read_b64_tr_b16 v[108:109], v202 offset:2560
  v_mfma_f32_16x16x32_bf16 v[134:137], v[90:93], v[50:53], v[134:137]
  ds_read_b128 v[66:69], v198 offset:22528
  v_mfma_f32_16x16x32_bf16 v[154:157], v[50:53], v[94:97], v[154:157]
  ds_read_b128 v[70:73], v196 offset:16384
  s_waitcnt lgkmcnt(8)
  v_mfma_f32_16x16x32_bf16 v[178:181], v[190:193], v[54:57], v[178:181]
  ds_read_b128 v[74:77], v196 offset:24576
  buffer_load_dwordx4 v225, s[12:15], s62 offen offset:2048 lds
  v_mfma_f32_16x16x32_bf16 v[118:121], v[86:89], v[54:57], v[118:121]
  ds_read_b128 v[78:81], v196 offset:3072
  v_mfma_f32_16x16x32_bf16 v[138:141], v[90:93], v[54:57], v[138:141]
  ds_read_b128 v[82:85], v196 offset:11264
  v_mfma_f32_16x16x32_bf16 v[158:161], v[54:57], v[94:97], v[158:161]
  buffer_load_dwordx4 v226, s[12:15], s62 offen offset:3072 lds
  s_add_u32 m0, s44, 81920
  v_mfma_f32_16x16x32_bf16 v[182:185], v[190:193], v[58:61], v[182:185]
  s_mov_b32 s62, 393216
  v_mfma_f32_16x16x32_bf16 v[122:125], v[86:89], v[58:61], v[122:125]
  v_mfma_f32_16x16x32_bf16 v[142:145], v[90:93], v[58:61], v[142:145]
  buffer_load_dwordx4 v223, s[12:15], s62 offen offset:0 lds
  v_mfma_f32_16x16x32_bf16 v[162:165], v[58:61], v[94:97], v[162:165]
  v_mfma_f32_16x16x32_bf16 v[186:189], v[190:193], v[62:65], v[186:189]
  v_mfma_f32_16x16x32_bf16 v[126:129], v[86:89], v[62:65], v[126:129]
  buffer_load_dwordx4 v224, s[12:15], s62 offen offset:1024 lds
  v_mfma_f32_16x16x32_bf16 v[146:149], v[90:93], v[62:65], v[146:149]
  v_mfma_f32_16x16x32_bf16 v[166:169], v[62:65], v[94:97], v[166:169]
  s_waitcnt lgkmcnt(0)
  s_waitcnt vmcnt(14)
  s_barrier
  v_mfma_f32_16x16x32_bf16 v[110:113], v[98:101], v[66:69], v[110:113]
  ds_read_b64_tr_b16 v[86:87], v201 offset:32768
  buffer_load_dwordx4 v225, s[12:15], s62 offen offset:2048 lds
  v_mfma_f32_16x16x32_bf16 v[130:133], v[102:105], v[66:69], v[130:133]
  ds_read_b64_tr_b16 v[88:89], v201 offset:33280
  v_mfma_f32_16x16x32_bf16 v[150:153], v[66:69], v[106:109], v[150:153]
  ds_read_b64_tr_b16 v[90:91], v201 offset:33792
  v_mfma_f32_16x16x32_bf16 v[114:117], v[98:101], v[70:73], v[114:117]
  ds_read_b64_tr_b16 v[92:93], v201 offset:34304
  buffer_load_dwordx4 v226, s[12:15], s62 offen offset:3072 lds
  v_mfma_f32_16x16x32_bf16 v[134:137], v[102:105], v[70:73], v[134:137]
  ds_read_b64_tr_b16 v[94:95], v201 offset:34816
  v_mfma_f32_16x16x32_bf16 v[154:157], v[70:73], v[106:109], v[154:157]
  ds_read_b64_tr_b16 v[96:97], v201 offset:35328
  v_mfma_f32_16x16x32_bf16 v[118:121], v[98:101], v[74:77], v[118:121]
  ds_read_b128 v[46:49], v197 offset:23552
  buffer_load_dword v5, v10, s[24:27], 0 offen
  v_mfma_f32_16x16x32_bf16 v[138:141], v[102:105], v[74:77], v[138:141]
  ds_read_b128 v[50:53], v195 offset:49152
  v_mfma_f32_16x16x32_bf16 v[158:161], v[74:77], v[106:109], v[158:161]
  ds_read_b128 v[54:57], v195 offset:57344
  v_mfma_f32_16x16x32_bf16 v[122:125], v[98:101], v[78:81], v[122:125]
  ds_read_b128 v[58:61], v195 offset:35840
  buffer_load_dword v5, v10, s[24:27], s63 offen
  v_mfma_f32_16x16x32_bf16 v[142:145], v[102:105], v[78:81], v[142:145]
  ds_read_b128 v[62:65], v195 offset:44032
  v_mfma_f32_16x16x32_bf16 v[162:165], v[78:81], v[106:109], v[162:165]
  v_mfma_f32_16x16x32_bf16 v[126:129], v[98:101], v[82:85], v[126:129]
  buffer_load_dword v5, v11, s[24:27], 0 offen
  v_mfma_f32_16x16x32_bf16 v[146:149], v[102:105], v[82:85], v[146:149]
  v_mfma_f32_16x16x32_bf16 v[166:169], v[82:85], v[106:109], v[166:169]
  s_waitcnt lgkmcnt(4)
  v_mfma_f32_16x16x32_bf16 v[110:113], v[86:89], v[46:49], v[110:113]
  ds_read_b64_tr_b16 v[98:99], v202 offset:32768
  buffer_load_dword v5, v9, s[96:99], 0 offen
  v_add_u32 v9, 262144, v9
  v_mfma_f32_16x16x32_bf16 v[130:133], v[90:93], v[46:49], v[130:133]
  ds_read_b64_tr_b16 v[100:101], v202 offset:33280
  v_mfma_f32_16x16x32_bf16 v[150:153], v[46:49], v[94:97], v[150:153]
  ds_read_b64_tr_b16 v[102:103], v202 offset:33792
  v_mfma_f32_16x16x32_bf16 v[170:173], v[190:193], v[46:49], v[170:173]
  ds_read_b64_tr_b16 v[104:105], v202 offset:34304
  s_waitcnt lgkmcnt(4)
  v_mfma_f32_16x16x32_bf16 v[174:177], v[190:193], v[50:53], v[174:177]
  ds_read_b64_tr_b16 v[106:107], v202 offset:34816
  global_load_dword v5, v3, s[32:33]
  v_mfma_f32_16x16x32_bf16 v[178:181], v[190:193], v[54:57], v[178:181]
  ds_read_b64_tr_b16 v[108:109], v202 offset:35328
  v_mfma_f32_16x16x32_bf16 v[182:185], v[190:193], v[58:61], v[182:185]
  ds_read_b128 v[66:69], v198 offset:23552
  v_mfma_f32_16x16x32_bf16 v[186:189], v[190:193], v[62:65], v[186:189]
  ds_read_b128 v[70:73], v196 offset:49152
  global_load_dword v5, v4, s[34:35]
  v_mfma_f32_16x16x32_bf16 v[114:117], v[86:89], v[50:53], v[114:117]
  ds_read_b128 v[74:77], v196 offset:57344
  s_add_u32 m0, s44, 98304
  v_mfma_f32_16x16x32_bf16 v[134:137], v[90:93], v[50:53], v[134:137]
  ds_read_b128 v[78:81], v196 offset:35840
  v_mfma_f32_16x16x32_bf16 v[154:157], v[50:53], v[94:97], v[154:157]
  ds_read_b128 v[82:85], v196 offset:44032
  buffer_load_dwordx4 v15, s[16:19], s57 offen offset:0 lds
  v_mfma_f32_16x16x32_bf16 v[118:121], v[86:89], v[54:57], v[118:121]
  v_mfma_f32_16x16x32_bf16 v[138:141], v[90:93], v[54:57], v[138:141]
  v_cndmask_b32 v229, v170, v171, s[66:67]
  v_cndmask_b32 v229, v229, v172, s[68:69]
  v_cndmask_b32 v229, v229, v173, s[70:71]
  v_mfma_f32_16x16x32_bf16 v[158:161], v[54:57], v[94:97], v[158:161]
  v_cndmask_b32 v230, v174, v175, s[66:67]
  v_cndmask_b32 v230, v230, v176, s[68:69]
  v_cndmask_b32 v230, v230, v177, s[70:71]
  v_mfma_f32_16x16x32_bf16 v[122:125], v[86:89], v[58:61], v[122:125]
  v_cndmask_b32 v231, v178, v179, s[66:67]
  v_cndmask_b32 v231, v231, v180, s[68:69]
  v_cndmask_b32 v231, v231, v181, s[70:71]
  v_mfma_f32_16x16x32_bf16 v[142:145], v[90:93], v[58:61], v[142:145]
  v_cndmask_b32 v232, v182, v183, s[66:67]
  v_cndmask_b32 v232, v232, v184, s[68:69]
  v_cndmask_b32 v232, v232, v185, s[70:71]
  v_mfma_f32_16x16x32_bf16 v[162:165], v[58:61], v[94:97], v[162:165]
  v_cndmask_b32 v233, v186, v187, s[66:67]
  v_cndmask_b32 v233, v233, v188, s[68:69]
  v_cndmask_b32 v233, v233, v189, s[70:71]
  v_mfma_f32_16x16x32_bf16 v[126:129], v[86:89], v[62:65], v[126:129]
  ds_write_b32 v203, v229 offset:16384
  ds_write_b32 v203, v230 offset:16640
  v_mfma_f32_16x16x32_bf16 v[146:149], v[90:93], v[62:65], v[146:149]
  ds_write_b32 v203, v231 offset:16896
  ds_write_b32 v203, v232 offset:17152
  v_mfma_f32_16x16x32_bf16 v[166:169], v[62:65], v[94:97], v[166:169]
  ds_write_b32 v203, v233 offset:17408
  buffer_load_dwordx4 v16, s[16:19], s57 offen offset:1024 lds
L_loopE:
  s_waitcnt lgkmcnt(0)
  s_barrier
  ds_read_b128 v[234:237], v216 offset:16384
  ds_read_b128 v[238:241], v217 offset:17408
  v_mfma_f32_16x16x32_bf16 v[110:113], v[98:101], v[66:69], v[110:113]
  v_mfma_f32_16x16x32_bf16 v[130:133], v[102:105], v[66:69], v[130:133]
  v_mfma_f32_16x16x32_bf16 v[150:153], v[66:69], v[106:109], v[150:153]
  buffer_load_dword v12, v44, s[24:27], 0 offen offset:0 sc1
  v_mfma_f32_16x16x32_bf16 v[114:117], v[98:101], v[70:73], v[114:117]
  v_mfma_f32_16x16x32_bf16 v[134:137], v[102:105], v[70:73], v[134:137]
  s_waitcnt lgkmcnt(0)
  s_mov_b32 s49, 0x3b000000
  s_mov_b32 s50, 0x3727c5ac
  v_mfma_f32_16x16x32_bf16 v[154:157], v[70:73], v[106:109], v[154:157]
  v_add_f32 v234, v234, v235
  v_add_f32 v236, v236, v237
  v_mfma_f32_16x16x32_bf16 v[118:121], v[98:101], v[74:77], v[118:121]
  v_add_f32 v238, v238, v239
  v_add_f32 v240, v240, v241
  v_mfma_f32_16x16x32_bf16 v[138:141], v[102:105], v[74:77], v[138:141]
  v_mul_f32 v234, s49, v234
  v_mov_b32 v237, s50
  v_mfma_f32_16x16x32_bf16 v[158:161], v[74:77], v[106:109], v[158:161]
  v_mul_f32 v238, s49, v238
  v_mov_b32 v241, s50
  v_mfma_f32_16x16x32_bf16 v[122:125], v[98:101], v[78:81], v[122:125]
  v_fmac_f32 v237, s49, v236
  v_fma_f32 v237, -v234, v234, v237
  v_mfma_f32_16x16x32_bf16 v[142:145], v[102:105], v[78:81], v[142:145]
  v_fmac_f32 v241, s49, v240
  v_fma_f32 v241, -v238, v238, v241
  v_mfma_f32_16x16x32_bf16 v[162:165], v[78:81], v[106:109], v[162:165]
  v_max_f32 v237, s50, v237
  v_rsq_f32 v235, v237
  v_mfma_f32_16x16x32_bf16 v[126:129], v[98:101], v[82:85], v[126:129]
  v_max_f32 v241, s50, v241
  v_rsq_f32 v239, v241
  v_mfma_f32_16x16x32_bf16 v[146:149], v[102:105], v[82:85], v[146:149]
  v_mul_f32 v234, -v234, v235
  buffer_load_dwordx4 v17, s[16:19], s57 offen offset:2048 lds
  v_mfma_f32_16x16x32_bf16 v[166:169], v[82:85], v[106:109], v[166:169]
  v_mul_f32 v238, -v238, v239
  ds_write_b64 v222, v[234:235]
  ds_write2_b32 v218, v234, v235 offset0:160 offset1:240
  ds_write_b64 v220, v[238:239] offset:512
  ds_write2_b32 v219, v238, v239 offset0:160 offset1:240
  ds_read_b64 v[46:47], v220 offset:0
  ds_read_b64 v[48:49], v220 offset:128
  ds_read_b64 v[50:51], v220 offset:256
  ds_read_b64 v[52:53], v220 offset:384
  ds_read_b64 v[54:55], v220 offset:512
  ds_read_b128 v[56:59], v221 offset:640
  ds_read_b128 v[76:79], v221 offset:960
  ds_read_b128 v[60:63], v221 offset:704
  ds_read_b128 v[80:83], v221 offset:1024
  ds_read_b128 v[64:67], v221 offset:768
  ds_read_b128 v[84:87], v221 offset:1088
  ds_read_b128 v[68:71], v221 offset:832
  ds_read_b128 v[88:91], v221 offset:1152
  ds_read_b128 v[72:75], v221 offset:896
  ds_read_b128 v[92:95], v221 offset:1216
  s_waitcnt vmcnt(18)
  s_barrier
  v_mov_b32_dpp v34, v110 row_newbcast:0 row_mask:0xf bank_mask:0xf
  ds_read_b64_tr_b16 a[16:17], v25 offset:0
  ds_read_b64_tr_b16 a[18:19], v25 offset:1024
  v_mov_b32_dpp v35, v111 row_newbcast:0 row_mask:0xf bank_mask:0xf
  buffer_load_dwordx4 v18, s[16:19], s57 offen offset:3072 lds
  v_mov_b32_dpp v36, v112 row_newbcast:0 row_mask:0xf bank_mask:0xf
  v_mov_b32_dpp v37, v113 row_newbcast:0 row_mask:0xf bank_mask:0xf
  v_mov_b32_dpp v96, v130 row_newbcast:0 row_mask:0xf bank_mask:0xf
  v_mov_b32_dpp v97, v131 row_newbcast:0 row_mask:0xf bank_mask:0xf
  v_mov_b32_dpp v98, v132 row_newbcast:0 row_mask:0xf bank_mask:0xf
  v_mov_b32_dpp v99, v133 row_newbcast:0 row_mask:0xf bank_mask:0xf
  ds_read_b64_tr_b16 a[20:21], v30 offset:0
  ds_read_b64_tr_b16 a[22:23], v30 offset:1024
  v_mov_b32 v100, v150
  v_mov_b32 v101, v150
  s_nop 1
  v_permlane32_swap_b32 v100, v101
  s_waitcnt lgkmcnt(15)
  v_pk_mul_f32 v[102:103], v[96:97], v[46:47] op_sel:[0,0] op_sel_hi:[1,0]
  v_pk_mul_f32 v[104:105], v[98:99], v[46:47] op_sel:[0,0] op_sel_hi:[1,0]
  ds_read_b64_tr_b16 a[24:25], v31 offset:0
  ds_read_b64_tr_b16 a[26:27], v31 offset:1024
  v_pk_fma_f32 v[130:131], v[130:131], v[46:47], v[102:103] op_sel:[0,1,0] op_sel_hi:[1,1,1]
  v_pk_fma_f32 v[132:133], v[132:133], v[46:47], v[104:105] op_sel:[0,1,0] op_sel_hi:[1,1,1]
  v_cvt_pk_bf16_f32 v178, v130, v131
  v_cvt_pk_bf16_f32 v179, v132, v133
  v_pk_mul_f32 v[102:103], v[96:97], v[48:49] op_sel:[0,0] op_sel_hi:[1,0]
  v_pk_mul_f32 v[104:105], v[98:99], v[48:49] op_sel:[0,0] op_sel_hi:[1,0]
  v_pk_fma_f32 v[134:135], v[134:135], v[48:49], v[102:103] op_sel:[0,1,0] op_sel_hi:[1,1,1]
  s_add_u32 m0, s44, 114688
  s_nop 0
  buffer_load_dwordx4 v15, s[16:19], s59 offen offset:0 lds
  v_pk_fma_f32 v[136:137], v[136:137], v[48:49], v[104:105] op_sel:[0,1,0] op_sel_hi:[1,1,1]
  ds_read_b64_tr_b16 a[28:29], v32 offset:0
  ds_read_b64_tr_b16 a[30:31], v32 offset:1024
  v_cvt_pk_bf16_f32 v180, v134, v135
  v_cvt_pk_bf16_f32 v181, v136, v137
  v_pk_mul_f32 v[102:103], v[34:35], v[48:49] op_sel:[0,0] op_sel_hi:[1,0]
  v_pk_mul_f32 v[104:105], v[36:37], v[48:49] op_sel:[0,0] op_sel_hi:[1,0]
  v_pk_fma_f32 v[114:115], v[114:115], v[48:49], v[102:103] op_sel:[0,1,0] op_sel_hi:[1,1,1]
  v_pk_fma_f32 v[116:117], v[116:117], v[48:49], v[104:105] op_sel:[0,1,0] op_sel_hi:[1,1,1]
  v_cvt_pk_bf16_f32 v170, v114, v115
  v_cvt_pk_bf16_f32 v171, v116, v117
  ds_read_b64_tr_b16 a[80:81], v25 offset:4096
  ds_read_b64_tr_b16 a[82:83], v25 offset:5120
  v_pk_mul_f32 v[102:103], v[96:97], v[50:51] op_sel:[0,0] op_sel_hi:[1,0]
  v_pk_mul_f32 v[104:105], v[98:99], v[50:51] op_sel:[0,0] op_sel_hi:[1,0]
  v_pk_fma_f32 v[138:139], v[138:139], v[50:51], v[102:103] op_sel:[0,1,0] op_sel_hi:[1,1,1]
  v_pk_fma_f32 v[140:141], v[140:141], v[50:51], v[104:105] op_sel:[0,1,0] op_sel_hi:[1,1,1]
  v_cvt_pk_bf16_f32 v182, v138, v139
  v_cvt_pk_bf16_f32 v183, v140, v141
  v_pk_mul_f32 v[102:103], v[34:35], v[50:51] op_sel:[0,0] op_sel_hi:[1,0]
  v_pk_mul_f32 v[104:105], v[36:37], v[50:51] op_sel:[0,0] op_sel_hi:[1,0]
  ds_read_b64_tr_b16 a[84:85], v30 offset:4096
  ds_read_b64_tr_b16 a[86:87], v30 offset:5120
  v_pk_fma_f32 v[118:119], v[118:119], v[50:51], v[102:103] op_sel:[0,1,0] op_sel_hi:[1,1,1]
  v_pk_fma_f32 v[120:121], v[120:121], v[50:51], v[104:105] op_sel:[0,1,0] op_sel_hi:[1,1,1]
  buffer_load_dwordx4 v16, s[16:19], s59 offen offset:1024 lds
  v_cvt_pk_bf16_f32 v172, v118, v119
  v_cvt_pk_bf16_f32 v173, v120, v121
  v_mfma_f32_16x16x16_bf16 v[106:109], v[180:181], v[170:171], v[204:207]
  ds_read_b64_tr_b16 a[88:89], v31 offset:4096
  ds_read_b64_tr_b16 a[90:91], v31 offset:5120
  v_mfma_f32_16x16x16_bf16 v[238:241], v[178:179], v[170:171], v[208:211]
  v_pk_mul_f32 v[102:103], v[96:97], v[52:53] op_sel:[0,0] op_sel_hi:[1,0]
  v_pk_mul_f32 v[104:105], v[98:99], v[52:53] op_sel:[0,0] op_sel_hi:[1,0]
  v_pk_fma_f32 v[142:143], v[142:143], v[52:53], v[102:103] op_sel:[0,1,0] op_sel_hi:[1,1,1]
  v_pk_fma_f32 v[144:145], v[144:145], v[52:53], v[104:105] op_sel:[0,1,0] op_sel_hi:[1,1,1]
  ds_read_b64_tr_b16 a[92:93], v32 offset:4096
  ds_read_b64_tr_b16 a[94:95], v32 offset:5120
  v_cvt_pk_bf16_f32 v184, v142, v143
  v_cvt_pk_bf16_f32 v185, v144, v145
  v_pk_mul_f32 v[102:103], v[34:35], v[52:53] op_sel:[0,0] op_sel_hi:[1,0]
  v_pk_mul_f32 v[104:105], v[36:37], v[52:53] op_sel:[0,0] op_sel_hi:[1,0]
  v_pk_fma_f32 v[122:123], v[122:123], v[52:53], v[102:103] op_sel:[0,1,0] op_sel_hi:[1,1,1]
  v_pk_fma_f32 v[124:125], v[124:125], v[52:53], v[104:105] op_sel:[0,1,0] op_sel_hi:[1,1,1]
  v_cvt_pk_bf16_f32 v174, v122, v123
  buffer_load_dwordx4 v17, s[16:19], s59 offen offset:2048 lds
  v_cvt_pk_bf16_f32 v175, v124, v125
  ds_read_b64_tr_b16 a[48:49], v25 offset:8192
  ds_read_b64_tr_b16 a[50:51], v25 offset:9216
  v_mfma_f32_16x16x16_bf16 v[216:219], v[182:183], v[172:173], v[204:207]
  v_mfma_f32_16x16x16_bf16 v[242:245], v[180:181], v[172:173], v[204:207]
  ds_read_b64_tr_b16 a[52:53], v30 offset:8192
  ds_read_b64_tr_b16 a[54:55], v30 offset:9216
  s_waitcnt lgkmcnt(15)
  v_pk_mul_f32 v[102:103], v[96:97], v[54:55] op_sel:[0,0] op_sel_hi:[1,0]
  v_pk_mul_f32 v[104:105], v[98:99], v[54:55] op_sel:[0,0] op_sel_hi:[1,0]
  v_pk_fma_f32 v[146:147], v[146:147], v[54:55], v[102:103] op_sel:[0,1,0] op_sel_hi:[1,1,1]
  v_pk_fma_f32 v[148:149], v[148:149], v[54:55], v[104:105] op_sel:[0,1,0] op_sel_hi:[1,1,1]
  v_cvt_pk_bf16_f32 v186, v146, v147
  v_cvt_pk_bf16_f32 v187, v148, v149
  v_pk_mul_f32 v[102:103], v[34:35], v[54:55] op_sel:[0,0] op_sel_hi:[1,0]
  ds_read_b64_tr_b16 a[56:57], v31 offset:8192
  ds_read_b64_tr_b16 a[58:59], v31 offset:9216
  v_pk_mul_f32 v[104:105], v[36:37], v[54:55] op_sel:[0,0] op_sel_hi:[1,0]
  v_pk_fma_f32 v[126:127], v[126:127], v[54:55], v[102:103] op_sel:[0,1,0] op_sel_hi:[1,1,1]
  buffer_load_dwordx4 v18, s[16:19], s59 offen offset:3072 lds
  v_pk_fma_f32 v[128:129], v[128:129], v[54:55], v[104:105] op_sel:[0,1,0] op_sel_hi:[1,1,1]
  v_cvt_pk_bf16_f32 v176, v126, v127
  v_cvt_pk_bf16_f32 v177, v128, v129
  v_mfma_f32_16x16x16_bf16 v[230:233], v[184:185], v[174:175], v[204:207]
  ds_read_b64_tr_b16 a[60:61], v32 offset:8192
  ds_read_b64_tr_b16 a[62:63], v32 offset:9216
  v_mfma_f32_16x16x16_bf16 v[246:249], v[182:183], v[174:175], v[204:207]
  v_pk_mul_f32 v[102:103], v[56:57], v[100:101] op_sel:[0,0] op_sel_hi:[1,0]
  v_pk_mul_f32 v[104:105], v[58:59], v[100:101] op_sel:[0,0] op_sel_hi:[1,0]
  v_pk_fma_f32 v[150:151], v[150:151], v[76:77], v[102:103]
  v_pk_fma_f32 v[152:153], v[152:153], v[78:79], v[104:105]
  ds_read_b64_tr_b16 a[112:113], v25 offset:12288
  ds_read_b64_tr_b16 a[114:115], v25 offset:13312
  v_cvt_pk_bf16_f32 v194, v150, v151
  v_cvt_pk_bf16_f32 v195, v152, v153
  v_mfma_f32_16x16x16_bf16 v[234:237], v[186:187], v[176:177], v[204:207]
  s_add_u32 m0, s80, 24576
  s_nop 0
  buffer_load_dwordx4 v227, s[4:7], 0 offen offset:0 lds
  v_mfma_f32_16x16x16_bf16 v[250:253], v[184:185], v[176:177], v[204:207]
  ds_read_b64_tr_b16 a[116:117], v30 offset:12288
  ds_read_b64_tr_b16 a[118:119], v30 offset:13312
  v_pk_mul_f32 v[102:103], v[60:61], v[100:101] op_sel:[0,0] op_sel_hi:[1,0]
  v_pk_mul_f32 v[104:105], v[62:63], v[100:101] op_sel:[0,0] op_sel_hi:[1,0]
  v_pk_fma_f32 v[154:155], v[154:155], v[80:81], v[102:103]
  v_pk_fma_f32 v[156:157], v[156:157], v[82:83], v[104:105]
  v_cvt_pk_bf16_f32 v196, v154, v155
  v_cvt_pk_bf16_f32 v197, v156, v157
  v_pk_mul_f32 v[102:103], v[64:65], v[100:101] op_sel:[0,0] op_sel_hi:[1,0]
  v_pk_mul_f32 v[104:105], v[66:67], v[100:101] op_sel:[0,0] op_sel_hi:[1,0]
  ds_read_b64_tr_b16 a[120:121], v31 offset:12288
  ds_read_b64_tr_b16 a[122:123], v31 offset:13312
  v_pk_fma_f32 v[158:159], v[158:159], v[84:85], v[102:103]
  v_pk_fma_f32 v[160:161], v[160:161], v[86:87], v[104:105]
  v_cvt_pk_bf16_f32 v198, v158, v159
  v_cvt_pk_bf16_f32 v199, v160, v161
  v_cndmask_b32 v106, v238, v106, s[72:73]
  v_cndmask_b32 v107, v239, v107, s[74:75]
  v_cndmask_b32 v108, v240, v108, s[76:77]
  v_cndmask_b32 v109, v241, v109, s[78:79]
  ds_read_b64_tr_b16 a[124:125], v32 offset:12288
  ds_read_b64_tr_b16 a[126:127], v32 offset:13312
  v_max3_f32 v33, v106, v107, v108
  buffer_load_dwordx4 v228, s[4:7], 0 offen offset:1024 lds
  v_max_f32 v33, v33, v109
  v_cndmask_b32 v216, v242, v216, s[72:73]
  v_cndmask_b32 v217, v243, v217, s[74:75]
  v_cndmask_b32 v218, v244, v218, s[76:77]
  v_cndmask_b32 v219, v245, v219, s[78:79]
  v_max3_f32 v45, v216, v217, v218
  ds_read_b64_tr_b16 a[144:145], v25 offset:16384
  ds_read_b64_tr_b16 a[146:147], v25 offset:17408
  v_max_f32 v45, v45, v219
  v_cndmask_b32 v230, v246, v230, s[72:73]
  v_cndmask_b32 v231, v247, v231, s[74:75]
  v_cndmask_b32 v232, v248, v232, s[76:77]
  v_cndmask_b32 v233, v249, v233, s[78:79]
  v_max3_f32 v188, v230, v231, v232
  v_max_f32 v188, v188, v233
  v_cndmask_b32 v234, v250, v234, s[72:73]
  ds_read_b64_tr_b16 a[148:149], v30 offset:16384
  ds_read_b64_tr_b16 a[150:151], v30 offset:17408
  v_cndmask_b32 v235, v251, v235, s[74:75]
  v_cndmask_b32 v236, v252, v236, s[76:77]
  v_cndmask_b32 v237, v253, v237, s[78:79]
  v_max3_f32 v189, v234, v235, v236
  v_max_f32 v189, v189, v237
  v_permlane32_swap_b32 v33, v45
  s_nop 0
  v_permlane32_swap_b32 v188, v189
  s_add_u32 m0, s44, 131072
  s_nop 0
  buffer_load_dwordx4 v15, s[16:19], s58 offen offset:0 lds
  v_max_f32 v33, v33, v45
  ds_read_b64_tr_b16 a[152:153], v31 offset:16384
  ds_read_b64_tr_b16 a[154:155], v31 offset:17408
  v_max_f32 v188, v188, v189
  v_pk_mul_f32 v[102:103], v[68:69], v[100:101] op_sel:[0,0] op_sel_hi:[1,0]
  v_pk_mul_f32 v[104:105], v[70:71], v[100:101] op_sel:[0,0] op_sel_hi:[1,0]
  v_pk_fma_f32 v[162:163], v[162:163], v[88:89], v[102:103]
  v_pk_fma_f32 v[164:165], v[164:165], v[90:91], v[104:105]
  v_cvt_pk_bf16_f32 v200, v162, v163
  v_cvt_pk_bf16_f32 v201, v164, v165
  v_permlane16_swap_b32 v33, v188
  ds_read_b64_tr_b16 a[156:157], v32 offset:16384
  ds_read_b64_tr_b16 a[158:159], v32 offset:17408
  s_mov_b32 s51, 0x3eb8aa3b
  s_mov_b32 s52, 0xbeb8aa3b
  v_max_f32 v33, v33, v188
  v_mul_f32 v33, s52, v33
  v_mov_b32 v188, v33
  v_pk_mul_f32 v[102:103], v[72:73], v[100:101] op_sel:[0,0] op_sel_hi:[1,0]
  v_pk_mul_f32 v[104:105], v[74:75], v[100:101] op_sel:[0,0] op_sel_hi:[1,0]
  v_pk_fma_f32 v[166:167], v[166:167], v[92:93], v[102:103]
  ds_read_b64_tr_b16 a[208:209], v25 offset:20480
  ds_read_b64_tr_b16 a[210:211], v25 offset:21504
  v_pk_fma_f32 v[168:169], v[168:169], v[94:95], v[104:105]
  v_cvt_pk_bf16_f32 v202, v166, v167
  buffer_load_dwordx4 v16, s[16:19], s58 offen offset:1024 lds
  v_cvt_pk_bf16_f32 v203, v168, v169
  v_permlane16_swap_b32 v33, v188
  v_mov_b32 v45, v33
  v_mov_b32 v189, v188
  s_nop 0
  v_permlane32_swap_b32 v33, v45
  ds_read_b64_tr_b16 a[212:213], v30 offset:20480
  ds_read_b64_tr_b16 a[214:215], v30 offset:21504
  v_permlane32_swap_b32 v188, v189
  v_mov_b32 v190, 0x4e804e80
  v_mov_b32 v191, 0x4e804e80
  v_fma_f32 v106, v106, s51, v33
  v_fma_f32 v107, v107, s51, v33
  v_fma_f32 v108, v108, s51, v33
  v_fma_f32 v109, v109, s51, v33
  v_exp_f32 v106, v106
  ds_read_b64_tr_b16 a[216:217], v31 offset:20480
  ds_read_b64_tr_b16 a[218:219], v31 offset:21504
  v_exp_f32 v107, v107
  v_exp_f32 v108, v108
  v_exp_f32 v109, v109
  buffer_load_dwordx4 v17, s[16:19], s58 offen offset:2048 lds
  v_cvt_pk_bf16_f32 v46, v106, v107
  ds_read_b64_tr_b16 a[220:221], v32 offset:20480
  ds_read_b64_tr_b16 a[222:223], v32 offset:21504
  v_cvt_pk_bf16_f32 v47, v108, v109
  v_and_b32 v238, v46, v214
  v_and_b32 v240, v46, v212
  v_and_b32 v239, v47, v215
  v_and_b32 v241, v47, v213
  v_mfma_f32_16x16x16_bf16 v[114:117], v[190:191], v[46:47], 0
  ds_read_b64_tr_b16 a[176:177], v25 offset:24576
  ds_read_b64_tr_b16 a[178:179], v25 offset:25600
  v_mfma_f32_16x16x32_bf16 v[106:109], v[194:197], v[238:241], 0
  v_fma_f32 v216, v216, s51, v45
  v_fma_f32 v217, v217, s51, v45
  v_fma_f32 v218, v218, s51, v45
  v_fma_f32 v219, v219, s51, v45
  ds_read_b64_tr_b16 a[180:181], v30 offset:24576
  ds_read_b64_tr_b16 a[182:183], v30 offset:25600
  v_exp_f32 v216, v216
  buffer_load_dwordx4 v18, s[16:19], s58 offen offset:3072 lds
  v_exp_f32 v217, v217
  v_exp_f32 v218, v218
  v_exp_f32 v219, v219
  ds_read_b64_tr_b16 a[184:185], v31 offset:24576
  ds_read_b64_tr_b16 a[186:187], v31 offset:25600
  v_cvt_pk_bf16_f32 v48, v216, v217
  v_cvt_pk_bf16_f32 v49, v218, v219
  v_and_b32 v242, v48, v214
  v_and_b32 v244, v48, v212
  v_and_b32 v243, v49, v215
  v_and_b32 v245, v49, v213
  v_mfma_f32_16x16x16_bf16 v[118:121], v[190:191], v[48:49], 0
  ds_read_b64_tr_b16 a[188:189], v32 offset:24576
  ds_read_b64_tr_b16 a[190:191], v32 offset:25600
  v_mfma_f32_16x16x32_bf16 v[216:219], v[196:199], v[242:245], 0
  v_fma_f32 v230, v230, s51, v188
  s_add_u32 m0, s44, 147456
  s_nop 0
  buffer_load_dwordx4 v15, s[16:19], s60 offen offset:0 lds
  v_fma_f32 v231, v231, s51, v188
  ds_read_b64_tr_b16 a[240:241], v25 offset:28672
  ds_read_b64_tr_b16 a[242:243], v25 offset:29696
  v_fma_f32 v232, v232, s51, v188
  v_fma_f32 v233, v233, s51, v188
  v_exp_f32 v230, v230
  v_exp_f32 v231, v231
  v_exp_f32 v232, v232
  ds_read_b64_tr_b16 a[244:245], v30 offset:28672
  ds_read_b64_tr_b16 a[246:247], v30 offset:29696
  v_exp_f32 v233, v233
  v_cvt_pk_bf16_f32 v50, v230, v231
  v_cvt_pk_bf16_f32 v51, v232, v233
  v_and_b32 v246, v50, v214
  v_and_b32 v248, v50, v212
  v_and_b32 v247, v51, v215
  v_and_b32 v249, v51, v213
  ds_read_b64_tr_b16 a[248:249], v31 offset:28672
  ds_read_b64_tr_b16 a[250:251], v31 offset:29696
  v_mfma_f32_16x16x16_bf16 v[122:125], v[190:191], v[50:51], 0
  buffer_load_dwordx4 v16, s[16:19], s60 offen offset:1024 lds
  v_mfma_f32_16x16x32_bf16 v[230:233], v[198:201], v[246:249], 0
  ds_read_b64_tr_b16 a[252:253], v32 offset:28672
  ds_read_b64_tr_b16 a[254:255], v32 offset:29696
  v_fma_f32 v234, v234, s51, v189
  v_fma_f32 v235, v235, s51, v189
  v_fma_f32 v236, v236, s51, v189
  v_fma_f32 v237, v237, s51, v189
  v_exp_f32 v234, v234
  v_exp_f32 v235, v235
  v_exp_f32 v236, v236
  v_exp_f32 v237, v237
  v_cvt_pk_bf16_f32 v52, v234, v235
  v_cvt_pk_bf16_f32 v53, v236, v237
  v_and_b32 v250, v52, v214
  v_and_b32 v252, v52, v212
  v_and_b32 v251, v53, v215
  v_and_b32 v253, v53, v213
  v_mfma_f32_16x16x16_bf16 v[126:129], v[190:191], v[52:53], 0
  buffer_load_dwordx4 v17, s[16:19], s60 offen offset:2048 lds
  v_mfma_f32_16x16x32_bf16 v[234:237], v[200:203], v[250:253], 0
  s_waitcnt vmcnt(15)
  v_cmp_ne_u32 vcc, v14, v12
  s_nop 0
  s_mov_b32 s47, vcc_lo
  v_rcp_f32 v114, v114
  s_nop 0
  v_pk_mul_f32 v[106:107], v[106:107], v[114:115] op_sel:[0,0] op_sel_hi:[1,0]
  v_pk_mul_f32 v[108:109], v[108:109], v[114:115] op_sel:[0,0] op_sel_hi:[1,0]
  v_cvt_pk_bf16_f32 v130, v106, v107
  v_cvt_pk_bf16_f32 v131, v108, v109
  v_rcp_f32 v118, v118
  s_nop 0
  v_pk_mul_f32 v[216:217], v[216:217], v[118:119] op_sel:[0,0] op_sel_hi:[1,0]
  v_pk_mul_f32 v[218:219], v[218:219], v[118:119] op_sel:[0,0] op_sel_hi:[1,0]
  v_cvt_pk_bf16_f32 v132, v216, v217
  v_cvt_pk_bf16_f32 v133, v218, v219
  s_nop 0
  v_permlane32_swap_b32 v130, v132
  v_permlane32_swap_b32 v131, v133
  v_xor_b32 v130, v130, v26
  v_xor_b32 v131, v131, v27
  v_xor_b32 v132, v132, v28
  v_xor_b32 v133, v133, v29
  s_cmp_eq_u32 s47, 0
  s_cbranch_scc0 L_ss1
  buffer_store_dwordx4 v[130:133], v10, s[24:27], 0 offen
L_ss1_e:
  v_rcp_f32 v122, v122
  s_nop 0
  v_pk_mul_f32 v[230:231], v[230:231], v[122:123] op_sel:[0,0] op_sel_hi:[1,0]
  v_pk_mul_f32 v[232:233], v[232:233], v[122:123] op_sel:[0,0] op_sel_hi:[1,0]
  v_cvt_pk_bf16_f32 v134, v230, v231
  v_cvt_pk_bf16_f32 v135, v232, v233
  v_rcp_f32 v126, v126
  s_nop 0
  v_pk_mul_f32 v[234:235], v[234:235], v[126:127] op_sel:[0,0] op_sel_hi:[1,0]
  v_pk_mul_f32 v[236:237], v[236:237], v[126:127] op_sel:[0,0] op_sel_hi:[1,0]
  v_cvt_pk_bf16_f32 v136, v234, v235
  v_cvt_pk_bf16_f32 v137, v236, v237
  s_nop 0
  v_permlane32_swap_b32 v134, v136
  v_permlane32_swap_b32 v135, v137
  v_xor_b32 v134, v134, v26
  v_xor_b32 v135, v135, v27
  v_xor_b32 v136, v136, v28
  v_xor_b32 v137, v137, v29
  s_cmp_eq_u32 s47, 0
  s_cbranch_scc0 L_ss2
  buffer_store_dwordx4 v[134:137], v10, s[24:27], s63 offen
L_ss2_e:
  buffer_load_dwordx4 v18, s[16:19], s60 offen offset:3072 lds
  s_nop 1
  s_lshl_b32 s41, s65, 14
  v_lshrrev_b32 v1, 1, v6
  v_or_b32 v1, 3, v1
  v_lshl_add_u32 v13, v1, 9, s41
  v_and_b32 v1, 3, v6
  v_lshl_add_u32 v13, v1, 4, v13
  v_lshl_add_u32 v12, v6, 4, s41
  s_mov_b32 s50, 0x30800000
  v_and_b32 v2, 14, v7
  v_xor_b32 v1, v8, v2
  v_lshlrev_b32 v1, 3, v1
  v_lshl_add_u32 v1, v7, 7, v1
  v_add_u32 v1, s80, v1
  s_waitcnt vmcnt(10)
  ds_read_b64 v[38:39], v1 offset:24576
  v_xor_b32 v2, 32, v1
  ds_read_b64 v[40:41], v2 offset:24576
  v_xor_b32 v2, 64, v1
  ds_read_b64 v[42:43], v2 offset:24576
  v_xor_b32 v2, 96, v1
  ds_read_b64 v[44:45], v2 offset:24576
  s_waitcnt lgkmcnt(0)
  s_barrier
  ds_read_b64_tr_b16 v[176:177], v25 offset:32768
  ds_read_b64_tr_b16 v[178:179], v25 offset:33792
  ds_read_b64_tr_b16 v[180:181], v30 offset:32768
  ds_read_b64_tr_b16 v[182:183], v30 offset:33792
  ds_read_b64_tr_b16 v[184:185], v31 offset:32768
  ds_read_b64_tr_b16 v[186:187], v31 offset:33792
  ds_read_b64_tr_b16 v[188:189], v32 offset:32768
  ds_read_b64_tr_b16 v[190:191], v32 offset:33792
  ds_read_b64_tr_b16 v[160:161], v25 offset:36864
  ds_read_b64_tr_b16 v[162:163], v25 offset:37888
  ds_read_b64_tr_b16 v[164:165], v30 offset:36864
  ds_read_b64_tr_b16 v[166:167], v30 offset:37888
  ds_read_b64_tr_b16 v[168:169], v31 offset:36864
  ds_read_b64_tr_b16 v[170:171], v31 offset:37888
  ds_read_b64_tr_b16 v[172:173], v32 offset:36864
  ds_read_b64_tr_b16 v[174:175], v32 offset:37888
  v_lshlrev_b32 v48, 16, v38
  v_and_b32 v49, 0xffff0000, v38
  v_lshlrev_b32 v50, 16, v39
  v_and_b32 v51, 0xffff0000, v39
  v_lshlrev_b32 v52, 16, v40
  v_and_b32 v53, 0xffff0000, v40
  v_lshlrev_b32 v54, 16, v41
  v_and_b32 v55, 0xffff0000, v41
  v_lshlrev_b32 v56, 16, v42
  v_and_b32 v57, 0xffff0000, v42
  v_lshlrev_b32 v58, 16, v43
  v_and_b32 v59, 0xffff0000, v43
  v_lshlrev_b32 v60, 16, v44
  v_and_b32 v61, 0xffff0000, v44
  v_lshlrev_b32 v62, 16, v45
  v_and_b32 v63, 0xffff0000, v45
  v_mul_f32 v48, s50, v48
  v_mul_f32 v49, s50, v49
  v_mul_f32 v50, s50, v50
  v_mul_f32 v51, s50, v51
  v_mul_f32 v52, s50, v52
  v_mul_f32 v53, s50, v53
  v_mul_f32 v54, s50, v54
  v_mul_f32 v55, s50, v55
  v_mul_f32 v56, s50, v56
  v_mul_f32 v57, s50, v57
  v_mul_f32 v58, s50, v58
  v_mul_f32 v59, s50, v59
  v_mul_f32 v60, s50, v60
  v_mul_f32 v61, s50, v61
  v_mul_f32 v62, s50, v62
  v_mul_f32 v63, s50, v63
  ds_read_b64_tr_b16 v[144:145], v25 offset:40960
  ds_read_b64_tr_b16 v[146:147], v25 offset:41984
  ds_read_b64_tr_b16 v[148:149], v30 offset:40960
  ds_read_b64_tr_b16 v[150:151], v30 offset:41984
  ds_read_b64_tr_b16 v[152:153], v31 offset:40960
  ds_read_b64_tr_b16 v[154:155], v31 offset:41984
  ds_read_b64_tr_b16 v[156:157], v32 offset:40960
  ds_read_b64_tr_b16 v[158:159], v32 offset:41984
  ds_read_b64_tr_b16 v[128:129], v25 offset:45056
  ds_read_b64_tr_b16 v[130:131], v25 offset:46080
  ds_read_b64_tr_b16 v[132:133], v30 offset:45056
  ds_read_b64_tr_b16 v[134:135], v30 offset:46080
  ds_read_b64_tr_b16 v[136:137], v31 offset:45056
  ds_read_b64_tr_b16 v[138:139], v31 offset:46080
  ds_read_b64_tr_b16 v[140:141], v32 offset:45056
  ds_read_b64_tr_b16 v[142:143], v32 offset:46080
  buffer_load_dwordx4 v[34:37], v13, s[24:27], 0 offen sc1
  s_mov_b32 s49, 0
  buffer_load_dwordx4 v[192:195], v12, s[24:27], s49 offen offset:0 sc1
  buffer_load_dwordx4 v[196:199], v12, s[24:27], s49 offen offset:1024 sc1
  buffer_load_dwordx4 v[200:203], v12, s[24:27], s49 offen offset:2048 sc1
  buffer_load_dwordx4 v[204:207], v12, s[24:27], s49 offen offset:3072 sc1
  ds_read_b64_tr_b16 v[112:113], v25 offset:49152
  ds_read_b64_tr_b16 v[114:115], v25 offset:50176
  ds_read_b64_tr_b16 v[116:117], v30 offset:49152
  ds_read_b64_tr_b16 v[118:119], v30 offset:50176
  ds_read_b64_tr_b16 v[120:121], v31 offset:49152
  ds_read_b64_tr_b16 v[122:123], v31 offset:50176
  ds_read_b64_tr_b16 v[124:125], v32 offset:49152
  ds_read_b64_tr_b16 v[126:127], v32 offset:50176
  ds_read_b64_tr_b16 v[96:97], v25 offset:53248
  ds_read_b64_tr_b16 v[98:99], v25 offset:54272
  ds_read_b64_tr_b16 v[100:101], v30 offset:53248
  ds_read_b64_tr_b16 v[102:103], v30 offset:54272
  ds_read_b64_tr_b16 v[104:105], v31 offset:53248
  ds_read_b64_tr_b16 v[106:107], v31 offset:54272
  ds_read_b64_tr_b16 v[108:109], v32 offset:53248
  ds_read_b64_tr_b16 v[110:111], v32 offset:54272
  ds_read_b64_tr_b16 v[80:81], v25 offset:57344
  ds_read_b64_tr_b16 v[82:83], v25 offset:58368
  ds_read_b64_tr_b16 v[84:85], v30 offset:57344
  ds_read_b64_tr_b16 v[86:87], v30 offset:58368
  ds_read_b64_tr_b16 v[88:89], v31 offset:57344
  ds_read_b64_tr_b16 v[90:91], v31 offset:58368
  ds_read_b64_tr_b16 v[92:93], v32 offset:57344
  ds_read_b64_tr_b16 v[94:95], v32 offset:58368
  ds_read_b64_tr_b16 v[64:65], v25 offset:61440
  ds_read_b64_tr_b16 v[66:67], v25 offset:62464
  ds_read_b64_tr_b16 v[68:69], v30 offset:61440
  ds_read_b64_tr_b16 v[70:71], v30 offset:62464
  ds_read_b64_tr_b16 v[72:73], v31 offset:61440
  ds_read_b64_tr_b16 v[74:75], v31 offset:62464
  ds_read_b64_tr_b16 v[76:77], v32 offset:61440
  ds_read_b64_tr_b16 v[78:79], v32 offset:62464
  s_waitcnt vmcnt(4)
  v_xor_b32 v34, v34, v26
  v_xor_b32 v35, v35, v27
  v_xor_b32 v36, v36, v28
  v_xor_b32 v37, v37, v29
  v_or3_b32 v14, v34, v35, v36
  v_bitop3_b32 v14, v14, v37, s81 bitop3:0xa8
  v_cmp_ne_u32 vcc, 0, v14
  s_cbranch_vccz L_oe3
L_op4:
  buffer_load_dwordx4 v[34:37], v13, s[24:27], 0 offen sc1
  s_mov_b32 s49, 0
  buffer_load_dwordx4 v[192:195], v12, s[24:27], s49 offen offset:0 sc1
  buffer_load_dwordx4 v[196:199], v12, s[24:27], s49 offen offset:1024 sc1
  buffer_load_dwordx4 v[200:203], v12, s[24:27], s49 offen offset:2048 sc1
  buffer_load_dwordx4 v[204:207], v12, s[24:27], s49 offen offset:3072 sc1
  s_waitcnt vmcnt(4)
  v_xor_b32 v34, v34, v26
  v_xor_b32 v35, v35, v27
  v_xor_b32 v36, v36, v28
  v_xor_b32 v37, v37, v29
  v_or3_b32 v14, v34, v35, v36
  v_bitop3_b32 v14, v14, v37, s81 bitop3:0xa8
  v_cmp_ne_u32 vcc, 0, v14
  s_cbranch_vccz L_op4_ok
  s_add_u32 s43, s43, 1
  s_cmp_lt_u32 s43, 30000
  s_cbranch_scc1 L_op4
L_op4_ok:
L_oe3:
  s_mov_b32 s49, 4096
  buffer_load_dwordx4 v[208:211], v12, s[24:27], s49 offen offset:0 sc1
  buffer_load_dwordx4 v[212:215], v12, s[24:27], s49 offen offset:1024 sc1
  buffer_load_dwordx4 v[216:219], v12, s[24:27], s49 offen offset:2048 sc1
  buffer_load_dwordx4 v[220:223], v12, s[24:27], s49 offen offset:3072 sc1
  s_mov_b32 s49, 8192
  buffer_load_dwordx4 v[224:227], v12, s[24:27], s49 offen offset:0 sc1
  buffer_load_dwordx4 v[228:231], v12, s[24:27], s49 offen offset:1024 sc1
  buffer_load_dwordx4 v[232:235], v12, s[24:27], s49 offen offset:2048 sc1
  buffer_load_dwordx4 v[236:239], v12, s[24:27], s49 offen offset:3072 sc1
  s_mov_b32 s49, 12288
  buffer_load_dwordx4 v[240:243], v12, s[24:27], s49 offen offset:0 sc1
  buffer_load_dwordx4 v[244:247], v12, s[24:27], s49 offen offset:1024 sc1
  buffer_load_dwordx4 v[248:251], v12, s[24:27], s49 offen offset:2048 sc1
  buffer_load_dwordx4 v[252:255], v12, s[24:27], s49 offen offset:3072 sc1
L_oe3_k:
  s_waitcnt vmcnt(14)
  v_xor_b32 v192, v192, v26
  v_xor_b32 v193, v193, v27
  v_xor_b32 v194, v194, v28
  v_xor_b32 v195, v195, v29
  v_xor_b32 v196, v196, v26
  v_xor_b32 v197, v197, v27
  v_xor_b32 v198, v198, v28
  v_xor_b32 v199, v199, v29
  v_or3_b32 v14, v192, v193, v194
  v_or3_b32 v14, v14, v195, v196
  v_or3_b32 v14, v14, v197, v198
  v_bitop3_b32 v14, v14, v199, s81 bitop3:0xa8
  v_cmp_ne_u32 vcc, 0, v14
  s_cbranch_vccnz L_sl5
L_sl5_b:
  v_mfma_f32_16x16x32_bf16 v[48:51], a[16:19], v[192:195], v[48:51]
  s_waitcnt vmcnt(12)
  v_xor_b32 v200, v200, v26
  s_add_u32 m0, s44, 16384
  v_mfma_f32_16x16x32_bf16 v[52:55], a[20:23], v[192:195], v[52:55]
  v_xor_b32 v201, v201, v27
  v_xor_b32 v202, v202, v28
  s_sub_u32 s45, 1379840, s60
  v_mfma_f32_16x16x32_bf16 v[56:59], a[24:27], v[192:195], v[56:59]
  v_xor_b32 v203, v203, v29
  v_xor_b32 v204, v204, v26
  buffer_load_dwordx4 v15, s[16:19], s45 offen offset:0 lds
  v_mfma_f32_16x16x32_bf16 v[60:63], a[28:31], v[192:195], v[60:63]
  v_xor_b32 v205, v205, v27
  v_xor_b32 v206, v206, v28
  v_mfma_f32_16x16x32_bf16 v[48:51], a[80:83], v[196:199], v[48:51]
  v_xor_b32 v207, v207, v29
  v_or3_b32 v14, v200, v201, v202
  v_mfma_f32_16x16x32_bf16 v[52:55], a[84:87], v[196:199], v[52:55]
  v_or3_b32 v14, v14, v203, v204
  v_or3_b32 v14, v14, v205, v206
  v_mfma_f32_16x16x32_bf16 v[56:59], a[88:91], v[196:199], v[56:59]
  v_bitop3_b32 v14, v14, v207, s81 bitop3:0xa8
  v_cmp_ne_u32 vcc, 0, v14
  buffer_load_dwordx4 v16, s[16:19], s45 offen offset:1024 lds
  v_mfma_f32_16x16x32_bf16 v[60:63], a[92:95], v[196:199], v[60:63]
  s_cbranch_vccnz L_sl6
L_sl6_b:
  v_mfma_f32_16x16x32_bf16 v[48:51], a[48:51], v[200:203], v[48:51]
  s_waitcnt vmcnt(12)
  v_xor_b32 v208, v208, v26
  v_mfma_f32_16x16x32_bf16 v[52:55], a[52:55], v[200:203], v[52:55]
  v_xor_b32 v209, v209, v27
  v_xor_b32 v210, v210, v28
  v_mfma_f32_16x16x32_bf16 v[56:59], a[56:59], v[200:203], v[56:59]
  v_xor_b32 v211, v211, v29
  v_xor_b32 v212, v212, v26
  buffer_load_dwordx4 v17, s[16:19], s45 offen offset:2048 lds
  v_mfma_f32_16x16x32_bf16 v[60:63], a[60:63], v[200:203], v[60:63]
  v_xor_b32 v213, v213, v27
  v_xor_b32 v214, v214, v28
  v_mfma_f32_16x16x32_bf16 v[48:51], a[112:115], v[204:207], v[48:51]
  v_xor_b32 v215, v215, v29
  v_or3_b32 v14, v208, v209, v210
  v_mfma_f32_16x16x32_bf16 v[52:55], a[116:119], v[204:207], v[52:55]
  v_or3_b32 v14, v14, v211, v212
  v_or3_b32 v14, v14, v213, v214
  v_mfma_f32_16x16x32_bf16 v[56:59], a[120:123], v[204:207], v[56:59]
  v_bitop3_b32 v14, v14, v215, s81 bitop3:0xa8
  v_cmp_ne_u32 vcc, 0, v14
  buffer_load_dwordx4 v18, s[16:19], s45 offen offset:3072 lds
  v_mfma_f32_16x16x32_bf16 v[60:63], a[124:127], v[204:207], v[60:63]
  s_cbranch_vccnz L_sl7
L_sl7_b:
  s_add_u32 m0, s44, 32768
  v_mfma_f32_16x16x32_bf16 v[48:51], a[144:147], v[208:211], v[48:51]
  s_waitcnt vmcnt(12)
  v_xor_b32 v216, v216, v26
  s_sub_u32 s45, 1379840, s58
  v_mfma_f32_16x16x32_bf16 v[52:55], a[148:151], v[208:211], v[52:55]
  v_xor_b32 v217, v217, v27
  v_xor_b32 v218, v218, v28
  v_mfma_f32_16x16x32_bf16 v[56:59], a[152:155], v[208:211], v[56:59]
  v_xor_b32 v219, v219, v29
  v_xor_b32 v220, v220, v26
  buffer_load_dwordx4 v15, s[16:19], s45 offen offset:0 lds
  v_mfma_f32_16x16x32_bf16 v[60:63], a[156:159], v[208:211], v[60:63]
  v_xor_b32 v221, v221, v27
  v_xor_b32 v222, v222, v28
  v_mfma_f32_16x16x32_bf16 v[48:51], a[208:211], v[212:215], v[48:51]
  v_xor_b32 v223, v223, v29
  v_or3_b32 v14, v216, v217, v218
  v_mfma_f32_16x16x32_bf16 v[52:55], a[212:215], v[212:215], v[52:55]
  v_or3_b32 v14, v14, v219, v220
  v_or3_b32 v14, v14, v221, v222
  v_mfma_f32_16x16x32_bf16 v[56:59], a[216:219], v[212:215], v[56:59]
  v_bitop3_b32 v14, v14, v223, s81 bitop3:0xa8
  v_cmp_ne_u32 vcc, 0, v14
  buffer_load_dwordx4 v16, s[16:19], s45 offen offset:1024 lds
  v_mfma_f32_16x16x32_bf16 v[60:63], a[220:223], v[212:215], v[60:63]
  s_cbranch_vccnz L_sl8
L_sl8_b:
  v_mfma_f32_16x16x32_bf16 v[48:51], a[176:179], v[216:219], v[48:51]
  s_waitcnt vmcnt(12)
  v_xor_b32 v224, v224, v26
  v_mfma_f32_16x16x32_bf16 v[52:55], a[180:183], v[216:219], v[52:55]
  v_xor_b32 v225, v225, v27
  v_xor_b32 v226, v226, v28
  v_mfma_f32_16x16x32_bf16 v[56:59], a[184:187], v[216:219], v[56:59]
  v_xor_b32 v227, v227, v29
  v_xor_b32 v228, v228, v26
  buffer_load_dwordx4 v17, s[16:19], s45 offen offset:2048 lds
  v_mfma_f32_16x16x32_bf16 v[60:63], a[188:191], v[216:219], v[60:63]
  v_xor_b32 v229, v229, v27
  v_xor_b32 v230, v230, v28
  v_mfma_f32_16x16x32_bf16 v[48:51], a[240:243], v[220:223], v[48:51]
  v_xor_b32 v231, v231, v29
  v_or3_b32 v14, v224, v225, v226
  v_mfma_f32_16x16x32_bf16 v[52:55], a[244:247], v[220:223], v[52:55]
  v_or3_b32 v14, v14, v227, v228
  v_or3_b32 v14, v14, v229, v230
  v_mfma_f32_16x16x32_bf16 v[56:59], a[248:251], v[220:223], v[56:59]
  v_bitop3_b32 v14, v14, v231, s81 bitop3:0xa8
  v_cmp_ne_u32 vcc, 0, v14
  buffer_load_dwordx4 v18, s[16:19], s45 offen offset:3072 lds
  v_mfma_f32_16x16x32_bf16 v[60:63], a[252:255], v[220:223], v[60:63]
  s_cbranch_vccnz L_sl9
L_sl9_b:
  s_waitcnt lgkmcnt(15)
  v_mfma_f32_16x16x32_bf16 v[48:51], v[176:179], v[224:227], v[48:51]
  s_waitcnt vmcnt(12)
  v_xor_b32 v232, v232, v26
  v_mfma_f32_16x16x32_bf16 v[52:55], v[180:183], v[224:227], v[52:55]
  v_xor_b32 v233, v233, v27
  v_xor_b32 v234, v234, v28
  v_mfma_f32_16x16x32_bf16 v[56:59], v[184:187], v[224:227], v[56:59]
  v_xor_b32 v235, v235, v29
  v_xor_b32 v236, v236, v26
  v_mfma_f32_16x16x32_bf16 v[60:63], v[188:191], v[224:227], v[60:63]
  v_xor_b32 v237, v237, v27
  v_xor_b32 v238, v238, v28
  v_mfma_f32_16x16x32_bf16 v[48:51], v[160:163], v[228:231], v[48:51]
  v_xor_b32 v239, v239, v29
  v_or3_b32 v14, v232, v233, v234
  v_mfma_f32_16x16x32_bf16 v[52:55], v[164:167], v[228:231], v[52:55]
  v_or3_b32 v14, v14, v235, v236
  v_or3_b32 v14, v14, v237, v238
  v_mfma_f32_16x16x32_bf16 v[56:59], v[168:171], v[228:231], v[56:59]
  v_bitop3_b32 v14, v14, v239, s81 bitop3:0xa8
  v_cmp_ne_u32 vcc, 0, v14
  v_mfma_f32_16x16x32_bf16 v[60:63], v[172:175], v[228:231], v[60:63]
  s_cbranch_vccnz L_sl10
L_sl10_b:
  v_mfma_f32_16x16x32_bf16 v[48:51], v[144:147], v[232:235], v[48:51]
  s_waitcnt vmcnt(10)
  v_xor_b32 v240, v240, v26
  v_mfma_f32_16x16x32_bf16 v[52:55], v[148:151], v[232:235], v[52:55]
  v_xor_b32 v241, v241, v27
  v_xor_b32 v242, v242, v28
  v_mfma_f32_16x16x32_bf16 v[56:59], v[152:155], v[232:235], v[56:59]
  v_xor_b32 v243, v243, v29
  v_xor_b32 v244, v244, v26
  v_mfma_f32_16x16x32_bf16 v[60:63], v[156:159], v[232:235], v[60:63]
  v_xor_b32 v245, v245, v27
  v_xor_b32 v246, v246, v28
  v_mfma_f32_16x16x32_bf16 v[48:51], v[128:131], v[236:239], v[48:51]
  v_xor_b32 v247, v247, v29
  v_or3_b32 v14, v240, v241, v242
  v_mfma_f32_16x16x32_bf16 v[52:55], v[132:135], v[236:239], v[52:55]
  v_or3_b32 v14, v14, v243, v244
  v_or3_b32 v14, v14, v245, v246
  v_mfma_f32_16x16x32_bf16 v[56:59], v[136:139], v[236:239], v[56:59]
  v_bitop3_b32 v14, v14, v247, s81 bitop3:0xa8
  v_cmp_ne_u32 vcc, 0, v14
  v_mfma_f32_16x16x32_bf16 v[60:63], v[140:143], v[236:239], v[60:63]
  s_cbranch_vccnz L_sl11
L_sl11_b:
  v_mfma_f32_16x16x32_bf16 v[48:51], v[112:115], v[240:243], v[48:51]
  s_waitcnt vmcnt(8)
  v_xor_b32 v248, v248, v26
  v_mfma_f32_16x16x32_bf16 v[52:55], v[116:119], v[240:243], v[52:55]
  v_xor_b32 v249, v249, v27
  v_xor_b32 v250, v250, v28
  v_mfma_f32_16x16x32_bf16 v[56:59], v[120:123], v[240:243], v[56:59]
  v_xor_b32 v251, v251, v29
  v_xor_b32 v252, v252, v26
  v_mfma_f32_16x16x32_bf16 v[60:63], v[124:127], v[240:243], v[60:63]
  v_xor_b32 v253, v253, v27
  v_xor_b32 v254, v254, v28
  v_mfma_f32_16x16x32_bf16 v[48:51], v[96:99], v[244:247], v[48:51]
  v_xor_b32 v255, v255, v29
  v_or3_b32 v14, v248, v249, v250
  v_mfma_f32_16x16x32_bf16 v[52:55], v[100:103], v[244:247], v[52:55]
  v_or3_b32 v14, v14, v251, v252
  v_or3_b32 v14, v14, v253, v254
  v_mfma_f32_16x16x32_bf16 v[56:59], v[104:107], v[244:247], v[56:59]
  v_bitop3_b32 v14, v14, v255, s81 bitop3:0xa8
  v_cmp_ne_u32 vcc, 0, v14
  v_mfma_f32_16x16x32_bf16 v[60:63], v[108:111], v[244:247], v[60:63]
  s_cbranch_vccnz L_sl12
L_sl12_b:
  s_waitcnt lgkmcnt(0)
  v_mfma_f32_16x16x32_bf16 v[48:51], v[80:83], v[248:251], v[48:51]
  v_mfma_f32_16x16x32_bf16 v[52:55], v[84:87], v[248:251], v[52:55]
  v_mfma_f32_16x16x32_bf16 v[56:59], v[88:91], v[248:251], v[56:59]
  v_mfma_f32_16x16x32_bf16 v[60:63], v[92:95], v[248:251], v[60:63]
  v_mfma_f32_16x16x32_bf16 v[48:51], v[64:67], v[252:255], v[48:51]
  v_mfma_f32_16x16x32_bf16 v[52:55], v[68:71], v[252:255], v[52:55]
  v_mfma_f32_16x16x32_bf16 v[56:59], v[72:75], v[252:255], v[56:59]
  v_mfma_f32_16x16x32_bf16 v[60:63], v[76:79], v[252:255], v[60:63]
  s_lshr_b32 s49, s46, 4
  v_mov_b32 v66, s49
  s_nop 2
  v_pk_add_f32 v[12:13], v[48:49], v[50:51]
  v_pk_mul_f32 v[30:31], v[48:49], v[48:49]
  v_pk_fma_f32 v[30:31], v[50:51], v[50:51], v[30:31]
  v_pk_add_f32 v[12:13], v[12:13], v[52:53]
  v_pk_fma_f32 v[30:31], v[52:53], v[52:53], v[30:31]
  v_pk_add_f32 v[12:13], v[12:13], v[54:55]
  v_pk_fma_f32 v[30:31], v[54:55], v[54:55], v[30:31]
  v_pk_add_f32 v[12:13], v[12:13], v[56:57]
  v_pk_fma_f32 v[30:31], v[56:57], v[56:57], v[30:31]
  v_pk_add_f32 v[12:13], v[12:13], v[58:59]
  v_pk_fma_f32 v[30:31], v[58:59], v[58:59], v[30:31]
  v_pk_add_f32 v[12:13], v[12:13], v[60:61]
  v_pk_fma_f32 v[30:31], v[60:61], v[60:61], v[30:31]
  v_pk_add_f32 v[12:13], v[12:13], v[62:63]
  v_pk_fma_f32 v[30:31], v[62:63], v[62:63], v[30:31]
  v_add_f32 v64, v12, v13
  v_add_f32 v65, v30, v31
  s_nop 1
  v_permlane32_swap_b32 v64, v65
  v_add_f32 v64, v64, v65
  v_mov_b32 v12, v64
  s_nop 1
  v_permlane16_swap_b32 v64, v12
  v_add_f32 v64, v64, v12
  v_mov_b32 v65, v64
  s_nop 1
  v_permlane32_swap_b32 v64, v65
  s_cmp_eq_u32 s47, 0
  s_cbranch_scc0 L_ss13
  buffer_store_dwordx3 v[64:66], v11, s[24:27], 0 offen
L_ss13_e:
  v_xor_b32 v25, 4096, v19
  v_xor_b32 v32, 4096, v20
  v_xor_b32 v47, 4096, v21
  v_xor_b32 v68, 4096, v22
  v_xor_b32 v69, 4096, v23
  v_xor_b32 v70, 4096, v24
  s_lshl_b32 s41, s38, 7
  s_add_u32 s41, s41, s65
  s_lshl_b32 s41, s41, 11
  s_add_u32 s41, s41, 2097152
  v_lshl_add_u32 v71, v6, 4, s41
  v_and_b32 v1, 7, v6
  v_and_b32 v2, 1, v8
  v_lshlrev_b32 v2, 2, v2
  v_xor_b32 v1, v1, v2
  v_lshrrev_b32 v2, 3, v6
  s_mul_i32 s41, s48, 14
  s_and_b32 s42, s3, 1
  s_add_u32 s41, s41, s42
  s_lshl_b32 s41, s41, 17
  s_lshl_b32 s42, s37, 7
  s_add_u32 s41, s41, s42
  v_lshl_add_u32 v1, v1, 4, s41
  v_lshl_add_u32 v72, v2, 12, v1
  v_add_u32 v73, 31744, v72
  v_add_u32 v74, 63488, v72
  v_add_u32 v75, 95232, v72
  s_lshr_b32 s51, s3, 1
  s_lshl_b32 s51, s51, 6
  s_and_b32 s52, s3, 1
  s_lshl_b32 s52, s52, 6
  v_lshrrev_b32 v27, 1, v27
  v_lshrrev_b32 v29, 1, v29
  v_or_b32 v26, v26, v27
  v_or_b32 v27, v28, v29
  v_not_b32 v28, v26
  v_not_b32 v29, v27
  v_lshl_add_u64 v[28:29], v[28:29], 0, 1
  s_mov_b32 s81, 0x60006000
  s_mov_b32 s50, 0x15800000
  v_lshrrev_b32 v1, 5, v6
  s_min_u32 s41, s40, 27
  s_lshl_b32 s41, s41, 7
  s_add_u32 s41, s41, s51
  v_lshl_add_u32 v1, v1, 3, s41
  global_load_dwordx2 v[38:39], v1, s[32:33] offset:0
  global_load_dwordx2 v[40:41], v1, s[32:33] offset:16
  global_load_dwordx2 v[42:43], v1, s[32:33] offset:32
  global_load_dwordx2 v[44:45], v1, s[32:33] offset:48
  v_and_b32 v46, 31, v6
  s_lshr_b32 s41, s51, 1
  v_add_u32 v46, s41, v46
  s_lshl_b32 s42, s37, 7
  v_lshl_add_u32 v1, v46, 1, s42
  global_load_ushort v33, v1, s[34:35]
  v_cvt_pk_bf16_f32 v76, v48, v49
  v_cvt_pk_bf16_f32 v77, v50, v51
  v_cvt_pk_bf16_f32 v78, v52, v53
  v_cvt_pk_bf16_f32 v79, v54, v55
  v_cvt_pk_bf16_f32 v80, v56, v57
  v_cvt_pk_bf16_f32 v81, v58, v59
  v_cvt_pk_bf16_f32 v82, v60, v61
  v_cvt_pk_bf16_f32 v83, v62, v63
  v_and_b32 v2, 14, v7
  v_xor_b32 v1, v8, v2
  v_lshlrev_b32 v1, 3, v1
  s_lshr_b32 s41, s51, 3
  s_add_u32 s41, s41, s44
  v_xor_b32 v1, s41, v1
  v_lshl_add_u32 v1, v7, 7, v1
  ds_write_b64 v1, v[76:77] offset:2048
  v_xor_b32 v2, 32, v1
  ds_write_b64 v2, v[78:79] offset:2048
  v_xor_b32 v2, 64, v1
  ds_write_b64 v2, v[80:81] offset:2048
  v_xor_b32 v2, 96, v1
  ds_write_b64 v2, v[82:83] offset:2048
  v_bfe_u32 v1, v7, 1, 1
  v_lshrrev_b32 v2, 2, v7
  v_lshl_add_u32 v1, v1, 2, v2
  v_and_b32 v2, 1, v7
  v_lshl_add_u32 v1, v1, 1, v2
  v_xor_b32 v1, v1, v8
  v_lshl_add_u32 v1, v1, 3, s44
  v_lshl_add_u32 v84, v7, 7, v1
  v_xor_b32 v85, 64, v84
  v_xor_b32 v88, 32, v84
  v_xor_b32 v89, 32, v85
  v_bfe_u32 v1, v7, 2, 1
  v_and_b32 v2, 2, v8
  v_or_b32 v1, v1, v2
  v_lshl_add_u32 v1, v1, 3, s51
  v_xor_b32 v86, v1, v19
  v_xor_b32 v87, 64, v86
  v_xor_b32 v90, 32, v86
  v_xor_b32 v91, 32, v87
  v_lshlrev_b32 v1, 4, v7
  v_lshl_add_u32 v1, v8, 9, v1
  v_add_u32 v92, s64, v1
  s_mov_b32 s53, 0x3b000000
  s_mov_b32 s54, 0x3f800054
  v_mov_b32 v93, 0x10dbe6ff
  ds_read_b64_tr_b16 a[0:1], v21 offset:32768
  ds_read_b64_tr_b16 a[2:3], v21 offset:33792
  ds_read_b64_tr_b16 a[4:5], v22 offset:32768
  ds_read_b64_tr_b16 a[6:7], v22 offset:33792
  ds_read_b64_tr_b16 a[8:9], v21 offset:34816
  ds_read_b64_tr_b16 a[10:11], v21 offset:35840
  ds_read_b64_tr_b16 a[12:13], v22 offset:34816
  ds_read_b64_tr_b16 a[14:15], v22 offset:35840
  ds_read_b64_tr_b16 a[16:17], v47 offset:32768
  ds_read_b64_tr_b16 a[18:19], v47 offset:33792
  ds_read_b64_tr_b16 a[20:21], v68 offset:32768
  ds_read_b64_tr_b16 a[22:23], v68 offset:33792
  ds_read_b64_tr_b16 a[24:25], v47 offset:34816
  ds_read_b64_tr_b16 a[26:27], v47 offset:35840
  ds_read_b64_tr_b16 a[28:29], v68 offset:34816
  ds_read_b64_tr_b16 a[30:31], v68 offset:35840
  buffer_load_dwordx3 v[94:96], v92, s[24:27], 0 offen offset:0 sc1
  buffer_load_dwordx3 v[98:100], v92, s[24:27], 0 offen offset:256 sc1
  ds_read_b64_tr_b16 a[64:65], v21 offset:49152
  ds_read_b64_tr_b16 a[66:67], v21 offset:50176
  ds_read_b64_tr_b16 a[68:69], v22 offset:49152
  ds_read_b64_tr_b16 a[70:71], v22 offset:50176
  ds_read_b64_tr_b16 a[72:73], v21 offset:51200
  ds_read_b64_tr_b16 a[74:75], v21 offset:52224
  ds_read_b64_tr_b16 a[76:77], v22 offset:51200
  ds_read_b64_tr_b16 a[78:79], v22 offset:52224
  ds_read_b64_tr_b16 a[80:81], v47 offset:49152
  ds_read_b64_tr_b16 a[82:83], v47 offset:50176
  ds_read_b64_tr_b16 a[84:85], v68 offset:49152
  ds_read_b64_tr_b16 a[86:87], v68 offset:50176
  ds_read_b64_tr_b16 a[88:89], v47 offset:51200
  ds_read_b64_tr_b16 a[90:91], v47 offset:52224
  ds_read_b64_tr_b16 a[92:93], v68 offset:51200
  ds_read_b64_tr_b16 a[94:95], v68 offset:52224
  s_waitcnt vmcnt(0)
  v_xor_b32 v1, s49, v96
  v_xor_b32 v2, s49, v100
  v_or_b32 v1, v1, v2
  v_cmp_ne_u32 vcc, 0, v1
  s_cbranch_vccz L_se14
L_st15:
  buffer_load_dwordx3 v[94:96], v92, s[24:27], 0 offen sc1
  buffer_load_dwordx3 v[98:100], v92, s[24:27], 0 offen offset:256 sc1
  s_waitcnt vmcnt(0)
  v_xor_b32 v1, s49, v96
  v_xor_b32 v2, s49, v100
  v_or_b32 v1, v1, v2
  v_cmp_ne_u32 vcc, 0, v1
  s_cbranch_vccz L_st15_ok
  s_add_u32 s43, s43, 1
  s_cmp_lt_u32 s43, 30000
  s_cbranch_scc1 L_st15
L_st15_ok:
L_se14:
  v_pk_add_f32 v[64:65], v[94:95], v[98:99]
  s_nop 1
  v_permlane32_swap_b32 v64, v65
  v_add_f32 v64, v64, v65
  v_mov_b32 v12, v64
  s_nop 1
  v_permlane16_swap_b32 v64, v12
  v_add_f32 v64, v64, v12
  v_mov_b32 v65, v64
  s_nop 1
  v_permlane32_swap_b32 v64, v65
  v_mul_f32 v64, s53, v64
  v_mul_f32 v65, s53, v65
  v_fma_f32 v65, -v64, v64, v65
  v_max_f32 v65, 0, v65
  v_fma_f32 v13, v65, s54, v93
  v_rsq_f32 v13, v13
  s_nop 0
  v_mul_f32 v31, s50, v13
  v_mul_f32 v30, -v64, v31
  s_waitcnt lgkmcnt(15)
  v_pk_fma_f32 v[48:49], v[48:49], v[30:31], v[30:31] op_sel:[0,1,0] op_sel_hi:[1,1,0]
  v_pk_fma_f32 v[50:51], v[50:51], v[30:31], v[30:31] op_sel:[0,1,0] op_sel_hi:[1,1,0]
  v_cvt_pk_bf16_f32 v76, v48, v49
  v_cvt_pk_bf16_f32 v77, v50, v51
  ds_write_b64 v84, v[76:77] offset:0
  v_pk_fma_f32 v[52:53], v[52:53], v[30:31], v[30:31] op_sel:[0,1,0] op_sel_hi:[1,1,0]
  v_pk_fma_f32 v[54:55], v[54:55], v[30:31], v[30:31] op_sel:[0,1,0] op_sel_hi:[1,1,0]
  v_cvt_pk_bf16_f32 v78, v52, v53
  v_cvt_pk_bf16_f32 v79, v54, v55
  ds_write_b64 v88, v[78:79]
  ds_read_b64_tr_b16 v[48:49], v86 offset:0
  ds_read_b64_tr_b16 v[50:51], v90 offset:1024
  v_pk_fma_f32 v[56:57], v[56:57], v[30:31], v[30:31] op_sel:[0,1,0] op_sel_hi:[1,1,0]
  v_pk_fma_f32 v[58:59], v[58:59], v[30:31], v[30:31] op_sel:[0,1,0] op_sel_hi:[1,1,0]
  v_cvt_pk_bf16_f32 v80, v56, v57
  v_cvt_pk_bf16_f32 v81, v58, v59
  ds_write_b64 v85, v[80:81] offset:0
  v_pk_fma_f32 v[60:61], v[60:61], v[30:31], v[30:31] op_sel:[0,1,0] op_sel_hi:[1,1,0]
  v_pk_fma_f32 v[62:63], v[62:63], v[30:31], v[30:31] op_sel:[0,1,0] op_sel_hi:[1,1,0]
  v_cvt_pk_bf16_f32 v82, v60, v61
  v_cvt_pk_bf16_f32 v83, v62, v63
  ds_write_b64 v89, v[82:83]
  ds_read_b64_tr_b16 v[52:53], v87 offset:0
  ds_read_b64_tr_b16 v[54:55], v91 offset:1024
  s_waitcnt lgkmcnt(4)
  v_lshl_add_u64 v[48:49], v[48:49], 0, v[26:27]
  buffer_store_dwordx4 v[48:51], v71, s[24:27], 0 offen offset:0 sc1
  s_waitcnt lgkmcnt(0)
  v_lshl_add_u64 v[52:53], v[52:53], 0, v[26:27]
  buffer_store_dwordx4 v[52:55], v71, s[24:27], 0 offen offset:1024 sc1
  s_barrier
  s_mov_b32 s54, 0x69800000
  s_mov_b32 s55, 0x69800000
  s_cmp_ge_u32 s2, 224
  s_cbranch_scc1 L_idle
  v_lshlrev_b32 v224, 16, v38
  s_add_u32 m0, s44, 49152
  s_sub_u32 s45, 1379840, s59
  buffer_load_dwordx4 v15, s[16:19], s45 offen offset:0 lds
  ds_read_b64_tr_b16 a[32:33], v23 offset:0
  ds_read_b64_tr_b16 a[34:35], v23 offset:1024
  ds_read_b64_tr_b16 a[36:37], v24 offset:0
  ds_read_b64_tr_b16 a[38:39], v24 offset:1024
  v_and_b32 v225, 0xffff0000, v38
  v_lshlrev_b32 v226, 16, v39
  v_and_b32 v227, 0xffff0000, v39
  v_lshlrev_b32 v228, 16, v40
  v_and_b32 v229, 0xffff0000, v40
  v_lshlrev_b32 v230, 16, v41
  v_and_b32 v231, 0xffff0000, v41
  v_lshlrev_b32 v232, 16, v42
  v_and_b32 v233, 0xffff0000, v42
  v_lshlrev_b32 v234, 16, v43
  buffer_load_dwordx4 v16, s[16:19], s45 offen offset:1024 lds
  ds_read_b64_tr_b16 a[40:41], v23 offset:2048
  ds_read_b64_tr_b16 a[42:43], v23 offset:3072
  ds_read_b64_tr_b16 a[44:45], v24 offset:2048
  ds_read_b64_tr_b16 a[46:47], v24 offset:3072
  v_and_b32 v235, 0xffff0000, v43
  v_lshlrev_b32 v236, 16, v44
  v_and_b32 v237, 0xffff0000, v44
  v_lshlrev_b32 v238, 16, v45
  v_and_b32 v239, 0xffff0000, v45
  v_mul_f32 v224, s50, v224
  v_mul_f32 v225, s50, v225
  v_mul_f32 v226, s50, v226
  v_mul_f32 v227, s50, v227
  v_mul_f32 v228, s50, v228
  buffer_load_dwordx4 v17, s[16:19], s45 offen offset:2048 lds
  ds_read_b64_tr_b16 a[48:49], v69 offset:0
  ds_read_b64_tr_b16 a[50:51], v69 offset:1024
  ds_read_b64_tr_b16 a[52:53], v70 offset:0
  ds_read_b64_tr_b16 a[54:55], v70 offset:1024
  v_mul_f32 v229, s50, v229
  v_mul_f32 v230, s50, v230
  v_mul_f32 v231, s50, v231
  v_mul_f32 v232, s50, v232
  v_mul_f32 v233, s50, v233
  v_mul_f32 v234, s50, v234
  v_mul_f32 v235, s50, v235
  v_mul_f32 v236, s50, v236
  v_mul_f32 v237, s50, v237
  v_mul_f32 v238, s50, v238
  buffer_load_dwordx4 v18, s[16:19], s45 offen offset:3072 lds
  ds_read_b64_tr_b16 a[56:57], v69 offset:2048
  ds_read_b64_tr_b16 a[58:59], v69 offset:3072
  ds_read_b64_tr_b16 a[60:61], v70 offset:2048
  ds_read_b64_tr_b16 a[62:63], v70 offset:3072
  v_mul_f32 v239, s50, v239
  s_xor_b32 s41, s39, 1
  s_lshl2_add_u32 s41, s41, s48
  s_lshl_b32 s41, s41, 16
  s_add_u32 s41, s41, 2097152
  v_lshrrev_b32 v1, 1, v6
  v_or_b32 v1, 9, v1
  v_lshl_add_u32 v39, v1, 11, s41
  v_and_b32 v1, 3, v6
  v_lshl_add_u32 v39, v1, 4, v39
  s_add_u32 m0, s44, 98304
  s_sub_u32 s45, 1379840, s57
  buffer_load_dwordx4 v15, s[16:19], s45 offen offset:0 lds
  ds_read_b64_tr_b16 a[96:97], v23 offset:16384
  ds_read_b64_tr_b16 a[98:99], v23 offset:17408
  ds_read_b64_tr_b16 a[100:101], v24 offset:16384
  ds_read_b64_tr_b16 a[102:103], v24 offset:17408
  v_add_u32 v39, 1024, v39
  s_lshl_b32 s42, s52, 4
  s_add_u32 s41, s41, s42
  v_lshl_add_u32 v38, v6, 4, s41
  v_xor_b32 v35, 262144, v38
  s_mul_i32 s41, s39, 28
  s_add_u32 s41, s41, s40
  s_lshl_b32 s41, s41, 13
  s_add_u32 s41, s41, s42
  s_lshl_b32 s42, s51, 6
  buffer_load_dwordx4 v16, s[16:19], s45 offen offset:1024 lds
  ds_read_b64_tr_b16 a[104:105], v23 offset:18432
  ds_read_b64_tr_b16 a[106:107], v23 offset:19456
  ds_read_b64_tr_b16 a[108:109], v24 offset:18432
  ds_read_b64_tr_b16 a[110:111], v24 offset:19456
  s_add_u32 s41, s41, s42
  s_add_u32 s41, s41, 4194304
  v_lshl_add_u32 v40, v6, 4, s41
  v_mov_b32 v42, 0xc0135761
  v_mov_b32 v43, 0xbdd2d3e8
  v_bfe_u32 v2, v6, 1, 4
  v_and_b32 v1, 14, v2
  v_lshrrev_b32 v3, 5, v6
  v_and_b32 v4, 1, v6
  v_xor_b32 v1, v1, v3
  buffer_load_dwordx4 v17, s[16:19], s45 offen offset:2048 lds
  ds_read_b64_tr_b16 a[112:113], v69 offset:16384
  ds_read_b64_tr_b16 a[114:115], v69 offset:17408
  ds_read_b64_tr_b16 a[116:117], v70 offset:16384
  ds_read_b64_tr_b16 a[118:119], v70 offset:17408
  v_xor_b32 v1, v1, v4
  v_lshlrev_b32 v1, 3, v1
  s_lshl_b32 s41, s51, 6
  s_add_u32 s41, s41, s52
  v_xor_b32 v1, s41, v1
  v_lshl_add_u32 v1, v2, 7, v1
  v_lshl_add_u32 v1, v4, 13, v1
  ds_read_b64 v[48:49], v1 offset:2048
  v_xor_b32 v2, 16, v1
  buffer_load_dwordx4 v18, s[16:19], s45 offen offset:3072 lds
  ds_read_b64_tr_b16 a[120:121], v69 offset:18432
  ds_read_b64_tr_b16 a[122:123], v69 offset:19456
  ds_read_b64_tr_b16 a[124:125], v70 offset:18432
  ds_read_b64_tr_b16 a[126:127], v70 offset:19456
  ds_read_b64 v[50:51], v2 offset:2048
  v_xor_b32 v2, 32, v1
  ds_read_b64 v[52:53], v2 offset:2048
  v_xor_b32 v2, 48, v1
  ds_read_b64 v[54:55], v2 offset:2048
  v_lshl_add_u32 v10, v6, 4, s44
  v_xor_b32 v11, 8192, v10
  ds_read_b64_tr_b16 a[128:129], v19 offset:16384
  ds_read_b64_tr_b16 a[130:131], v19 offset:17408
  ds_read_b64_tr_b16 a[132:133], v20 offset:16384
  ds_read_b64_tr_b16 a[134:135], v20 offset:17408
  s_lshl3_add_u32 s41, s65, s38
  s_lshl_b32 s41, s41, 11
  v_lshl_add_u32 v12, v6, 4, s41
  v_xor_b32 v13, 2048, v12
  s_lshl_b32 s49, s52, 6
  s_xor_b32 s41, s38, 1
  s_lshl2_add_u32 s41, s41, s48
  s_mul_i32 s41, s41, 57344
  s_add_u32 s41, s41, 4194304
  v_lshrrev_b32 v1, 2, v6
  ds_read_b64_tr_b16 a[136:137], v19 offset:18432
  ds_read_b64_tr_b16 a[138:139], v19 offset:19456
  ds_read_b64_tr_b16 a[140:141], v20 offset:18432
  ds_read_b64_tr_b16 a[142:143], v20 offset:19456
  v_min_u32 v1, 13, v1
  v_or_b32 v1, 1, v1
  v_lshl_add_u32 v31, v1, 12, s41
  v_and_b32 v1, 3, v6
  v_lshl_add_u32 v31, v1, 4, v31
  v_add_u32 v31, 2048, v31
  s_lshl_b32 s42, s52, 4
  s_add_u32 s41, s41, s42
  v_lshl_add_u32 v30, v6, 4, s41
  s_bitcmp1_b32 s38, 0
  s_cselect_b32 s41, 1, -1
  ds_read_b64_tr_b16 a[144:145], v25 offset:16384
  ds_read_b64_tr_b16 a[146:147], v25 offset:17408
  ds_read_b64_tr_b16 a[148:149], v32 offset:16384
  ds_read_b64_tr_b16 a[150:151], v32 offset:17408
  s_mul_i32 s41, s41, 229376
  v_add_u32 v14, s41, v30
  s_lshl_b32 s41, s37, 16
  s_lshl_b32 s42, s38, 7
  s_add_u32 s41, s41, s42
  s_add_u32 s41, s41, s52
  v_lshl_add_u32 v34, v46, 10, s41
  v_lshl_add_u32 v34, v3, 4, v34
  s_min_u32 s41, s2, 1
  s_lshl_b32 s41, s41, 23
  ds_read_b64_tr_b16 a[152:153], v25 offset:18432
  ds_read_b64_tr_b16 a[154:155], v25 offset:19456
  ds_read_b64_tr_b16 a[156:157], v32 offset:18432
  ds_read_b64_tr_b16 a[158:159], v32 offset:19456
  s_add_u32 s41, s41, 6819840
  v_lshl_add_u32 v36, v0, 23, s41
  v_mov_b32 v37, s46
  s_waitcnt lgkmcnt(15)
  v_lshlrev_b32 v33, 16, v33
  v_mul_f32 v33, s50, v33
  v_lshlrev_b32 v240, 16, v48
  v_and_b32 v241, 0xffff0000, v48
  v_lshlrev_b32 v242, 16, v49
  v_and_b32 v243, 0xffff0000, v49
  ds_read_b64_tr_b16 a[192:193], v19 offset:32768
  ds_read_b64_tr_b16 a[194:195], v19 offset:33792
  ds_read_b64_tr_b16 a[196:197], v20 offset:32768
  ds_read_b64_tr_b16 a[198:199], v20 offset:33792
  v_lshlrev_b32 v244, 16, v50
  buffer_load_dwordx2 v[56:57], v39, s[24:27], 0 offen sc1
  s_xor_b32 s53, s61, 0
  buffer_load_dwordx4 v[160:163], v38, s[24:27], s53 offen offset:0 sc1
  buffer_load_dwordx4 v[164:167], v38, s[24:27], s53 offen offset:2048 sc1
  s_xor_b32 s53, s61, 4096
  buffer_load_dwordx4 v[168:171], v38, s[24:27], s53 offen offset:0 sc1
  buffer_load_dwordx4 v[172:175], v38, s[24:27], s53 offen offset:2048 sc1
  s_xor_b32 s53, s61, 8192
  buffer_load_dwordx4 v[176:179], v38, s[24:27], s53 offen offset:0 sc1
  buffer_load_dwordx4 v[180:183], v38, s[24:27], s53 offen offset:2048 sc1
  s_xor_b32 s53, s61, 12288
  buffer_load_dwordx4 v[184:187], v38, s[24:27], s53 offen offset:0 sc1
  buffer_load_dwordx4 v[188:191], v38, s[24:27], s53 offen offset:2048 sc1
  s_xor_b32 s53, s61, 16384
  buffer_load_dwordx4 v[192:195], v38, s[24:27], s53 offen offset:0 sc1
  buffer_load_dwordx4 v[196:199], v38, s[24:27], s53 offen offset:2048 sc1
  v_and_b32 v245, 0xffff0000, v50
  v_lshlrev_b32 v246, 16, v51
  v_and_b32 v247, 0xffff0000, v51
  v_lshlrev_b32 v248, 16, v52
  v_and_b32 v249, 0xffff0000, v52
  v_lshlrev_b32 v250, 16, v53
  v_and_b32 v251, 0xffff0000, v53
  v_lshlrev_b32 v252, 16, v54
  v_and_b32 v253, 0xffff0000, v54
  ds_read_b64_tr_b16 a[200:201], v19 offset:34816
  ds_read_b64_tr_b16 a[202:203], v19 offset:35840
  ds_read_b64_tr_b16 a[204:205], v20 offset:34816
  ds_read_b64_tr_b16 a[206:207], v20 offset:35840
  v_lshlrev_b32 v254, 16, v55
  v_and_b32 v255, 0xffff0000, v55
  s_mov_b32 s41, 0x24800000
  v_fma_f32 v240, v240, s41, v33
  v_fma_f32 v241, v241, s41, v33
  v_fma_f32 v242, v242, s41, v33
  v_fma_f32 v243, v243, s41, v33
  v_fma_f32 v244, v244, s41, v33
  v_fma_f32 v245, v245, s41, v33
  v_fma_f32 v246, v246, s41, v33
  ds_read_b64_tr_b16 a[208:209], v25 offset:32768
  ds_read_b64_tr_b16 a[210:211], v25 offset:33792
  ds_read_b64_tr_b16 a[212:213], v32 offset:32768
  ds_read_b64_tr_b16 a[214:215], v32 offset:33792
  v_fma_f32 v247, v247, s41, v33
  v_fma_f32 v248, v248, s41, v33
  v_fma_f32 v249, v249, s41, v33
  v_fma_f32 v250, v250, s41, v33
  v_fma_f32 v251, v251, s41, v33
  v_fma_f32 v252, v252, s41, v33
  v_fma_f32 v253, v253, s41, v33
  v_fma_f32 v254, v254, s41, v33
  v_fma_f32 v255, v255, s41, v33
  ds_read_b64_tr_b16 a[216:217], v25 offset:34816
  ds_read_b64_tr_b16 a[218:219], v25 offset:35840
  ds_read_b64_tr_b16 a[220:221], v32 offset:34816
  ds_read_b64_tr_b16 a[222:223], v32 offset:35840
  v_xor_b32 v60, 0x40000000, v26
  v_xor_b32 v61, 0, v27
  v_not_b32 v62, v60
  v_not_b32 v63, v61
  v_lshl_add_u64 v[62:63], v[62:63], 0, 1
  s_waitcnt vmcnt(10)
  v_lshl_add_u64 v[56:57], v[56:57], 0, v[28:29]
  v_bitop3_b32 v41, v56, v57, s81 bitop3:0xa8
  v_cmp_ne_u32 vcc, 0, v41
  s_cbranch_vccnz L_p3p16
L_p3p16_b:
  s_xor_b32 s53, s61, 20480
  buffer_load_dwordx4 v[200:203], v38, s[24:27], s53 offen offset:0 sc1
  buffer_load_dwordx4 v[204:207], v38, s[24:27], s53 offen offset:2048 sc1
  s_xor_b32 s53, s61, 24576
  buffer_load_dwordx4 v[208:211], v38, s[24:27], s53 offen offset:0 sc1
  buffer_load_dwordx4 v[212:215], v38, s[24:27], s53 offen offset:2048 sc1
  s_waitcnt vmcnt(12)
  v_lshl_add_u64 v[160:161], v[160:161], 0, v[28:29]
  v_lshl_add_u64 v[164:165], v[164:165], 0, v[28:29]
  v_or3_b32 v41, v160, v161, v164
  v_bitop3_b32 v41, v41, v165, s81 bitop3:0xa8
  v_cmp_ne_u32 vcc, 0, v41
  s_cbranch_vccnz L_sl17
L_sl17_b:
  v_mfma_f32_32x32x16_bf16 v[112:127], a[0:3], v[160:163], 0
  s_xor_b32 s53, s61, 28672
  buffer_load_dwordx4 v[216:219], v38, s[24:27], s53 offen offset:0 sc1
  buffer_load_dwordx4 v[220:223], v38, s[24:27], s53 offen offset:2048 sc1
  v_mfma_f32_32x32x16_bf16 v[144:159], a[4:7], v[160:163], 0
  ds_read_b64_tr_b16 a[160:161], v19 offset:49152
  ds_read_b64_tr_b16 a[162:163], v19 offset:50176
  ds_read_b64_tr_b16 a[164:165], v20 offset:49152
  ds_read_b64_tr_b16 a[166:167], v20 offset:50176
  v_mfma_f32_32x32x16_bf16 v[112:127], a[8:11], v[164:167], v[112:127]
  s_waitcnt vmcnt(12)
  v_lshl_add_u64 v[168:169], v[168:169], 0, v[28:29]
  v_lshl_add_u64 v[172:173], v[172:173], 0, v[28:29]
  v_or3_b32 v41, v168, v169, v172
  v_bitop3_b32 v41, v41, v173, s81 bitop3:0xa8
  v_cmp_ne_u32 vcc, 0, v41
  v_mfma_f32_32x32x16_bf16 v[144:159], a[12:15], v[164:167], v[144:159]
  ds_read_b64_tr_b16 a[168:169], v19 offset:51200
  ds_read_b64_tr_b16 a[170:171], v19 offset:52224
  ds_read_b64_tr_b16 a[172:173], v20 offset:51200
  ds_read_b64_tr_b16 a[174:175], v20 offset:52224
  s_cbranch_vccnz L_sl18
L_sl18_b:
  v_mfma_f32_32x32x16_bf16 v[112:127], a[16:19], v[168:171], v[112:127]
  s_xor_b32 s53, s61, 32768
  buffer_load_dwordx4 v[160:163], v38, s[24:27], s53 offen offset:0 sc1
  buffer_load_dwordx4 v[164:167], v38, s[24:27], s53 offen offset:2048 sc1
  v_mfma_f32_32x32x16_bf16 v[144:159], a[20:23], v[168:171], v[144:159]
  ds_read_b64_tr_b16 a[224:225], v21 offset:32768
  ds_read_b64_tr_b16 a[226:227], v21 offset:33792
  ds_read_b64_tr_b16 a[228:229], v22 offset:32768
  ds_read_b64_tr_b16 a[230:231], v22 offset:33792
  v_mfma_f32_32x32x16_bf16 v[112:127], a[24:27], v[172:175], v[112:127]
  s_waitcnt vmcnt(12)
  v_lshl_add_u64 v[176:177], v[176:177], 0, v[28:29]
  v_lshl_add_u64 v[180:181], v[180:181], 0, v[28:29]
  v_or3_b32 v41, v176, v177, v180
  v_bitop3_b32 v41, v41, v181, s81 bitop3:0xa8
  v_cmp_ne_u32 vcc, 0, v41
  v_mfma_f32_32x32x16_bf16 v[144:159], a[28:31], v[172:175], v[144:159]
  ds_read_b64_tr_b16 a[232:233], v21 offset:34816
  ds_read_b64_tr_b16 a[234:235], v21 offset:35840
  ds_read_b64_tr_b16 a[236:237], v22 offset:34816
  ds_read_b64_tr_b16 a[238:239], v22 offset:35840
  s_cbranch_vccnz L_sl19
L_sl19_b:
  v_mfma_f32_32x32x16_bf16 v[112:127], a[32:35], v[176:179], v[112:127]
  s_xor_b32 s53, s61, 36864
  buffer_load_dwordx4 v[168:171], v38, s[24:27], s53 offen offset:0 sc1
  buffer_load_dwordx4 v[172:175], v38, s[24:27], s53 offen offset:2048 sc1
  s_waitcnt lgkmcnt(15)
  s_barrier
  v_mfma_f32_32x32x16_bf16 v[144:159], a[36:39], v[176:179], v[144:159]
  ds_read_b64_tr_b16 a[176:177], v25 offset:49152
  ds_read_b64_tr_b16 a[178:179], v25 offset:50176
  ds_read_b64_tr_b16 a[180:181], v32 offset:49152
  ds_read_b64_tr_b16 a[182:183], v32 offset:50176
  v_mfma_f32_32x32x16_bf16 v[112:127], a[40:43], v[180:183], v[112:127]
  s_waitcnt vmcnt(12)
  v_lshl_add_u64 v[184:185], v[184:185], 0, v[28:29]
  v_lshl_add_u64 v[188:189], v[188:189], 0, v[28:29]
  v_or3_b32 v41, v184, v185, v188
  v_bitop3_b32 v41, v41, v189, s81 bitop3:0xa8
  v_cmp_ne_u32 vcc, 0, v41
  v_mfma_f32_32x32x16_bf16 v[144:159], a[44:47], v[180:183], v[144:159]
  ds_read_b64_tr_b16 a[184:185], v25 offset:51200
  ds_read_b64_tr_b16 a[186:187], v25 offset:52224
  ds_read_b64_tr_b16 a[188:189], v32 offset:51200
  ds_read_b64_tr_b16 a[190:191], v32 offset:52224
  s_cbranch_vccnz L_sl20
L_sl20_b:
  v_mfma_f32_32x32x16_bf16 v[112:127], a[48:51], v[184:187], v[112:127]
  s_xor_b32 s53, s61, 40960
  buffer_load_dwordx4 v[176:179], v38, s[24:27], s53 offen offset:0 sc1
  buffer_load_dwordx4 v[180:183], v38, s[24:27], s53 offen offset:2048 sc1
  v_mfma_f32_32x32x16_bf16 v[144:159], a[52:55], v[184:187], v[144:159]
  ds_read_b64_tr_b16 a[240:241], v47 offset:32768
  ds_read_b64_tr_b16 a[242:243], v47 offset:33792
  ds_read_b64_tr_b16 a[244:245], v68 offset:32768
  ds_read_b64_tr_b16 a[246:247], v68 offset:33792
  v_mfma_f32_32x32x16_bf16 v[112:127], a[56:59], v[188:191], v[112:127]
  s_waitcnt vmcnt(12)
  v_lshl_add_u64 v[192:193], v[192:193], 0, v[28:29]
  v_lshl_add_u64 v[196:197], v[196:197], 0, v[28:29]
  v_or3_b32 v41, v192, v193, v196
  v_bitop3_b32 v41, v41, v197, s81 bitop3:0xa8
  v_cmp_ne_u32 vcc, 0, v41
  v_mfma_f32_32x32x16_bf16 v[144:159], a[60:63], v[188:191], v[144:159]
  ds_read_b64_tr_b16 a[248:249], v47 offset:34816
  ds_read_b64_tr_b16 a[250:251], v47 offset:35840
  ds_read_b64_tr_b16 a[252:253], v68 offset:34816
  ds_read_b64_tr_b16 a[254:255], v68 offset:35840
  s_cbranch_vccnz L_sl21
L_sl21_b:
  v_mfma_f32_32x32x16_bf16 v[112:127], a[64:67], v[192:195], v[112:127]
  s_xor_b32 s53, s61, 45056
  buffer_load_dwordx4 v[184:187], v38, s[24:27], s53 offen offset:0 sc1
  buffer_load_dwordx4 v[188:191], v38, s[24:27], s53 offen offset:2048 sc1
  v_mfma_f32_32x32x16_bf16 v[144:159], a[68:71], v[192:195], v[144:159]
  v_mfma_f32_32x32x16_bf16 v[112:127], a[72:75], v[196:199], v[112:127]
  s_waitcnt vmcnt(12)
  v_lshl_add_u64 v[200:201], v[200:201], 0, v[28:29]
  v_lshl_add_u64 v[204:205], v[204:205], 0, v[28:29]
  v_or3_b32 v41, v200, v201, v204
  v_bitop3_b32 v41, v41, v205, s81 bitop3:0xa8
  v_cmp_ne_u32 vcc, 0, v41
  v_mfma_f32_32x32x16_bf16 v[144:159], a[76:79], v[196:199], v[144:159]
  s_cbranch_vccnz L_sl22
L_sl22_b:
  v_mfma_f32_32x32x16_bf16 v[112:127], a[80:83], v[200:203], v[112:127]
  s_xor_b32 s53, s61, 0
  buffer_load_dwordx4 v[192:195], v35, s[24:27], s53 offen offset:0 sc1
  buffer_load_dwordx4 v[196:199], v35, s[24:27], s53 offen offset:2048 sc1
  v_mfma_f32_32x32x16_bf16 v[144:159], a[84:87], v[200:203], v[144:159]
  v_mfma_f32_32x32x16_bf16 v[112:127], a[88:91], v[204:207], v[112:127]
  s_waitcnt vmcnt(12)
  v_lshl_add_u64 v[208:209], v[208:209], 0, v[28:29]
  v_lshl_add_u64 v[212:213], v[212:213], 0, v[28:29]
  v_or3_b32 v41, v208, v209, v212
  v_bitop3_b32 v41, v41, v213, s81 bitop3:0xa8
  v_cmp_ne_u32 vcc, 0, v41
  v_mfma_f32_32x32x16_bf16 v[144:159], a[92:95], v[204:207], v[144:159]
  s_cbranch_vccnz L_sl23
L_sl23_b:
  v_mfma_f32_32x32x16_bf16 v[112:127], a[96:99], v[208:211], v[112:127]
  s_xor_b32 s53, s61, 49152
  buffer_load_dwordx4 v[200:203], v38, s[24:27], s53 offen offset:0 sc1
  buffer_load_dwordx4 v[204:207], v38, s[24:27], s53 offen offset:2048 sc1
  v_mfma_f32_32x32x16_bf16 v[144:159], a[100:103], v[208:211], v[144:159]
  v_mfma_f32_32x32x16_bf16 v[112:127], a[104:107], v[212:215], v[112:127]
  s_waitcnt vmcnt(12)
  v_lshl_add_u64 v[216:217], v[216:217], 0, v[28:29]
  v_lshl_add_u64 v[220:221], v[220:221], 0, v[28:29]
  v_or3_b32 v41, v216, v217, v220
  v_bitop3_b32 v41, v41, v221, s81 bitop3:0xa8
  v_cmp_ne_u32 vcc, 0, v41
  v_mfma_f32_32x32x16_bf16 v[144:159], a[108:111], v[212:215], v[144:159]
  s_cbranch_vccnz L_sl24
L_sl24_b:
  v_mfma_f32_32x32x16_bf16 v[112:127], a[112:115], v[216:219], v[112:127]
  s_xor_b32 s53, s61, 4096
  buffer_load_dwordx4 v[208:211], v35, s[24:27], s53 offen offset:0 sc1
  buffer_load_dwordx4 v[212:215], v35, s[24:27], s53 offen offset:2048 sc1
  v_mfma_f32_32x32x16_bf16 v[144:159], a[116:119], v[216:219], v[144:159]
  v_mfma_f32_32x32x16_bf16 v[112:127], a[120:123], v[220:223], v[112:127]
  s_waitcnt vmcnt(12)
  v_lshl_add_u64 v[160:161], v[160:161], 0, v[28:29]
  v_lshl_add_u64 v[164:165], v[164:165], 0, v[28:29]
  v_or3_b32 v41, v160, v161, v164
  v_bitop3_b32 v41, v41, v165, s81 bitop3:0xa8
  v_cmp_ne_u32 vcc, 0, v41
  v_mfma_f32_32x32x16_bf16 v[144:159], a[124:127], v[220:223], v[144:159]
  s_cbranch_vccnz L_sl25
L_sl25_b:
  v_mfma_f32_32x32x16_bf16 v[112:127], a[128:131], v[160:163], v[112:127]
  s_xor_b32 s53, s61, 53248
  buffer_load_dwordx4 v[216:219], v38, s[24:27], s53 offen offset:0 sc1
  buffer_load_dwordx4 v[220:223], v38, s[24:27], s53 offen offset:2048 sc1
  v_mfma_f32_32x32x16_bf16 v[144:159], a[132:135], v[160:163], v[144:159]
  v_mfma_f32_32x32x16_bf16 v[112:127], a[136:139], v[164:167], v[112:127]
  s_waitcnt vmcnt(12)
  v_lshl_add_u64 v[168:169], v[168:169], 0, v[28:29]
  v_lshl_add_u64 v[172:173], v[172:173], 0, v[28:29]
  v_or3_b32 v41, v168, v169, v172
  v_bitop3_b32 v41, v41, v173, s81 bitop3:0xa8
  v_cmp_ne_u32 vcc, 0, v41
  v_mfma_f32_32x32x16_bf16 v[144:159], a[140:143], v[164:167], v[144:159]
  s_cbranch_vccnz L_sl26
L_sl26_b:
  v_mfma_f32_32x32x16_bf16 v[112:127], a[144:147], v[168:171], v[112:127]
  s_xor_b32 s53, s61, 8192
  buffer_load_dwordx4 v[160:163], v35, s[24:27], s53 offen offset:0 sc1
  buffer_load_dwordx4 v[164:167], v35, s[24:27], s53 offen offset:2048 sc1
  v_mfma_f32_32x32x16_bf16 v[144:159], a[148:151], v[168:171], v[144:159]
  v_mfma_f32_32x32x16_bf16 v[112:127], a[152:155], v[172:175], v[112:127]
  s_waitcnt vmcnt(12)
  v_lshl_add_u64 v[176:177], v[176:177], 0, v[28:29]
  v_lshl_add_u64 v[180:181], v[180:181], 0, v[28:29]
  v_or3_b32 v41, v176, v177, v180
  v_bitop3_b32 v41, v41, v181, s81 bitop3:0xa8
  v_cmp_ne_u32 vcc, 0, v41
  v_mfma_f32_32x32x16_bf16 v[144:159], a[156:159], v[172:175], v[144:159]
  s_cbranch_vccnz L_sl27
L_sl27_b:
  s_waitcnt lgkmcnt(15)
  v_mfma_f32_32x32x16_bf16 v[112:127], a[160:163], v[176:179], v[112:127]
  s_xor_b32 s53, s61, 57344
  buffer_load_dwordx4 v[168:171], v38, s[24:27], s53 offen offset:0 sc1
  buffer_load_dwordx4 v[172:175], v38, s[24:27], s53 offen offset:2048 sc1
  v_mfma_f32_32x32x16_bf16 v[144:159], a[164:167], v[176:179], v[144:159]
  v_mfma_f32_32x32x16_bf16 v[112:127], a[168:171], v[180:183], v[112:127]
  s_waitcnt vmcnt(12)
  v_lshl_add_u64 v[184:185], v[184:185], 0, v[28:29]
  v_lshl_add_u64 v[188:189], v[188:189], 0, v[28:29]
  v_or3_b32 v41, v184, v185, v188
  v_bitop3_b32 v41, v41, v189, s81 bitop3:0xa8
  v_cmp_ne_u32 vcc, 0, v41
  v_mfma_f32_32x32x16_bf16 v[144:159], a[172:175], v[180:183], v[144:159]
  s_cbranch_vccnz L_sl28
L_sl28_b:
  s_waitcnt lgkmcnt(8)
  v_mfma_f32_32x32x16_bf16 v[112:127], a[176:179], v[184:187], v[112:127]
  s_xor_b32 s53, s61, 12288
  buffer_load_dwordx4 v[176:179], v35, s[24:27], s53 offen offset:0 sc1
  buffer_load_dwordx4 v[180:183], v35, s[24:27], s53 offen offset:2048 sc1
  v_mfma_f32_32x32x16_bf16 v[144:159], a[180:183], v[184:187], v[144:159]
  v_mfma_f32_32x32x16_bf16 v[112:127], a[184:187], v[188:191], v[112:127]
  s_waitcnt vmcnt(12)
  v_lshl_add_u64 v[192:193], v[192:193], 0, v[28:29]
  v_lshl_add_u64 v[196:197], v[196:197], 0, v[28:29]
  v_or3_b32 v41, v192, v193, v196
  v_bitop3_b32 v41, v41, v197, s81 bitop3:0xa8
  v_cmp_ne_u32 vcc, 0, v41
  v_mfma_f32_32x32x16_bf16 v[144:159], a[188:191], v[188:191], v[144:159]
  s_cbranch_vccnz L_sl29
L_sl29_b:
  v_mfma_f32_32x32x16_bf16 v[224:239], a[0:3], v[192:195], v[224:239]
  s_xor_b32 s53, s61, 61440
  buffer_load_dwordx4 v[184:187], v38, s[24:27], s53 offen offset:0 sc1
  buffer_load_dwordx4 v[188:191], v38, s[24:27], s53 offen offset:2048 sc1
  v_mfma_f32_32x32x16_bf16 v[128:143], a[4:7], v[192:195], 0
  v_mfma_f32_32x32x16_bf16 v[224:239], a[8:11], v[196:199], v[224:239]
  s_waitcnt vmcnt(12)
  v_lshl_add_u64 v[200:201], v[200:201], 0, v[28:29]
  v_lshl_add_u64 v[204:205], v[204:205], 0, v[28:29]
  v_or3_b32 v41, v200, v201, v204
  v_bitop3_b32 v41, v41, v205, s81 bitop3:0xa8
  v_cmp_ne_u32 vcc, 0, v41
  v_mfma_f32_32x32x16_bf16 v[128:143], a[12:15], v[196:199], v[128:143]
  s_cbranch_vccnz L_sl30
L_sl30_b:
  v_mfma_f32_32x32x16_bf16 v[112:127], a[192:195], v[200:203], v[112:127]
  s_xor_b32 s53, s61, 16384
  buffer_load_dwordx4 v[192:195], v35, s[24:27], s53 offen offset:0 sc1
  buffer_load_dwordx4 v[196:199], v35, s[24:27], s53 offen offset:2048 sc1
  v_mfma_f32_32x32x16_bf16 v[144:159], a[196:199], v[200:203], v[144:159]
  v_mfma_f32_32x32x16_bf16 v[112:127], a[200:203], v[204:207], v[112:127]
  s_waitcnt vmcnt(12)
  v_lshl_add_u64 v[208:209], v[208:209], 0, v[28:29]
  v_lshl_add_u64 v[212:213], v[212:213], 0, v[28:29]
  v_or3_b32 v41, v208, v209, v212
  v_bitop3_b32 v41, v41, v213, s81 bitop3:0xa8
  v_cmp_ne_u32 vcc, 0, v41
  v_mfma_f32_32x32x16_bf16 v[144:159], a[204:207], v[204:207], v[144:159]
  s_cbranch_vccnz L_sl31
L_sl31_b:
  v_mfma_f32_32x32x16_bf16 v[224:239], a[16:19], v[208:211], v[224:239]
  s_xor_b32 s53, s61, 20480
  buffer_load_dwordx4 v[200:203], v35, s[24:27], s53 offen offset:0 sc1
  buffer_load_dwordx4 v[204:207], v35, s[24:27], s53 offen offset:2048 sc1
  v_mfma_f32_32x32x16_bf16 v[128:143], a[20:23], v[208:211], v[128:143]
  v_mfma_f32_32x32x16_bf16 v[224:239], a[24:27], v[212:215], v[224:239]
  s_waitcnt vmcnt(12)
  v_lshl_add_u64 v[216:217], v[216:217], 0, v[28:29]
  v_lshl_add_u64 v[220:221], v[220:221], 0, v[28:29]
  v_or3_b32 v41, v216, v217, v220
  v_bitop3_b32 v41, v41, v221, s81 bitop3:0xa8
  v_cmp_ne_u32 vcc, 0, v41
  v_mfma_f32_32x32x16_bf16 v[128:143], a[28:31], v[212:215], v[128:143]
  s_cbranch_vccnz L_sl32
L_sl32_b:
  v_mfma_f32_32x32x16_bf16 v[112:127], a[208:211], v[216:219], v[112:127]
  s_xor_b32 s53, s61, 24576
  buffer_load_dwordx4 v[208:211], v35, s[24:27], s53 offen offset:0 sc1
  buffer_load_dwordx4 v[212:215], v35, s[24:27], s53 offen offset:2048 sc1
  v_mfma_f32_32x32x16_bf16 v[144:159], a[212:215], v[216:219], v[144:159]
  v_mfma_f32_32x32x16_bf16 v[112:127], a[216:219], v[220:223], v[112:127]
  s_waitcnt vmcnt(12)
  v_lshl_add_u64 v[160:161], v[160:161], 0, v[28:29]
  v_lshl_add_u64 v[164:165], v[164:165], 0, v[28:29]
  v_or3_b32 v41, v160, v161, v164
  v_bitop3_b32 v41, v41, v165, s81 bitop3:0xa8
  v_cmp_ne_u32 vcc, 0, v41
  v_mfma_f32_32x32x16_bf16 v[144:159], a[220:223], v[220:223], v[144:159]
  s_cbranch_vccnz L_sl33
L_sl33_b:
  v_mfma_f32_32x32x16_bf16 v[224:239], a[32:35], v[160:163], v[224:239]
  s_xor_b32 s53, s61, 28672
  buffer_load_dwordx4 v[216:219], v35, s[24:27], s53 offen offset:0 sc1
  buffer_load_dwordx4 v[220:223], v35, s[24:27], s53 offen offset:2048 sc1
  v_mfma_f32_32x32x16_bf16 v[128:143], a[36:39], v[160:163], v[128:143]
  v_mfma_f32_32x32x16_bf16 v[224:239], a[40:43], v[164:167], v[224:239]
  s_waitcnt vmcnt(12)
  v_lshl_add_u64 v[168:169], v[168:169], 0, v[28:29]
  v_lshl_add_u64 v[172:173], v[172:173], 0, v[28:29]
  v_or3_b32 v41, v168, v169, v172
  v_bitop3_b32 v41, v41, v173, s81 bitop3:0xa8
  v_cmp_ne_u32 vcc, 0, v41
  v_mfma_f32_32x32x16_bf16 v[128:143], a[44:47], v[164:167], v[128:143]
  s_cbranch_vccnz L_sl34
L_sl34_b:
  v_mfma_f32_32x32x16_bf16 v[112:127], a[224:227], v[168:171], v[112:127]
  s_xor_b32 s53, s61, 32768
  buffer_load_dwordx4 v[160:163], v35, s[24:27], s53 offen offset:0 sc1
  buffer_load_dwordx4 v[164:167], v35, s[24:27], s53 offen offset:2048 sc1
  v_mfma_f32_32x32x16_bf16 v[144:159], a[228:231], v[168:171], v[144:159]
  v_mfma_f32_32x32x16_bf16 v[112:127], a[232:235], v[172:175], v[112:127]
  s_waitcnt vmcnt(12)
  v_lshl_add_u64 v[176:177], v[176:177], 0, v[28:29]
  v_lshl_add_u64 v[180:181], v[180:181], 0, v[28:29]
  v_or3_b32 v41, v176, v177, v180
  v_bitop3_b32 v41, v41, v181, s81 bitop3:0xa8
  v_cmp_ne_u32 vcc, 0, v41
  v_mfma_f32_32x32x16_bf16 v[144:159], a[236:239], v[172:175], v[144:159]
  s_cbranch_vccnz L_sl35
L_sl35_b:
  v_mfma_f32_32x32x16_bf16 v[224:239], a[48:51], v[176:179], v[224:239]
  s_xor_b32 s53, s61, 36864
  buffer_load_dwordx4 v[168:171], v35, s[24:27], s53 offen offset:0 sc1
  buffer_load_dwordx4 v[172:175], v35, s[24:27], s53 offen offset:2048 sc1
  v_mfma_f32_32x32x16_bf16 v[128:143], a[52:55], v[176:179], v[128:143]
  v_mfma_f32_32x32x16_bf16 v[224:239], a[56:59], v[180:183], v[224:239]
  s_waitcnt vmcnt(12)
  v_lshl_add_u64 v[184:185], v[184:185], 0, v[28:29]
  v_lshl_add_u64 v[188:189], v[188:189], 0, v[28:29]
  v_or3_b32 v41, v184, v185, v188
  v_bitop3_b32 v41, v41, v189, s81 bitop3:0xa8
  v_cmp_ne_u32 vcc, 0, v41
  v_mfma_f32_32x32x16_bf16 v[128:143], a[60:63], v[180:183], v[128:143]
  s_cbranch_vccnz L_sl36
L_sl36_b:
  s_waitcnt lgkmcnt(0)
  v_mfma_f32_32x32x16_bf16 v[144:159], a[244:247], v[184:187], v[144:159]
  s_xor_b32 s53, s61, 40960
  buffer_load_dwordx4 v[176:179], v35, s[24:27], s53 offen offset:0 sc1
  buffer_load_dwordx4 v[180:183], v35, s[24:27], s53 offen offset:2048 sc1
  v_mfma_f32_32x32x16_bf16 v[112:127], a[240:243], v[184:187], v[112:127]
  v_mfma_f32_32x32x16_bf16 v[144:159], a[252:255], v[188:191], v[144:159]
  s_waitcnt vmcnt(12)
  v_lshl_add_u64 v[192:193], v[192:193], 0, v[28:29]
  v_lshl_add_u64 v[196:197], v[196:197], 0, v[28:29]
  v_or3_b32 v41, v192, v193, v196
  v_bitop3_b32 v41, v41, v197, s81 bitop3:0xa8
  v_cmp_ne_u32 vcc, 0, v41
  v_mfma_f32_32x32x16_bf16 v[112:127], a[248:251], v[188:191], v[112:127]
  s_cbranch_vccnz L_sl37
L_sl37_b:
  v_mfma_f32_32x32x16_bf16 v[224:239], a[64:67], v[192:195], v[224:239]
  s_xor_b32 s53, s61, 45056
  buffer_load_dwordx4 v[184:187], v35, s[24:27], s53 offen offset:0 sc1
  buffer_load_dwordx4 v[188:191], v35, s[24:27], s53 offen offset:2048 sc1
  v_mfma_f32_32x32x16_bf16 v[128:143], a[68:71], v[192:195], v[128:143]
  ds_write_b128 v10, v[144:147] offset:0
  v_mfma_f32_32x32x16_bf16 v[224:239], a[72:75], v[196:199], v[224:239]
  s_waitcnt vmcnt(12)
  v_lshl_add_u64 v[200:201], v[200:201], 0, v[28:29]
  v_lshl_add_u64 v[204:205], v[204:205], 0, v[28:29]
  v_or3_b32 v41, v200, v201, v204
  v_bitop3_b32 v41, v41, v205, s81 bitop3:0xa8
  v_cmp_ne_u32 vcc, 0, v41
  v_mfma_f32_32x32x16_bf16 v[128:143], a[76:79], v[196:199], v[128:143]
  ds_write_b128 v10, v[148:151] offset:1024
  s_cbranch_vccnz L_sl38
L_sl38_b:
  v_mfma_f32_32x32x16_bf16 v[224:239], a[80:83], v[200:203], v[224:239]
  s_xor_b32 s53, s61, 49152
  buffer_load_dwordx4 v[192:195], v35, s[24:27], s53 offen offset:0 sc1
  buffer_load_dwordx4 v[196:199], v35, s[24:27], s53 offen offset:2048 sc1
  ds_write_b128 v10, v[152:155] offset:2048
  v_mfma_f32_32x32x16_bf16 v[128:143], a[84:87], v[200:203], v[128:143]
  ds_write_b128 v10, v[156:159] offset:3072
  v_mfma_f32_32x32x16_bf16 v[224:239], a[88:91], v[204:207], v[224:239]
  s_waitcnt vmcnt(12)
  v_lshl_add_u64 v[208:209], v[208:209], 0, v[28:29]
  v_lshl_add_u64 v[212:213], v[212:213], 0, v[28:29]
  v_or3_b32 v41, v208, v209, v212
  v_bitop3_b32 v41, v41, v213, s81 bitop3:0xa8
  v_cmp_ne_u32 vcc, 0, v41
  v_mfma_f32_32x32x16_bf16 v[128:143], a[92:95], v[204:207], v[128:143]
  s_cbranch_vccnz L_sl39
L_sl39_b:
  v_mfma_f32_32x32x16_bf16 v[224:239], a[96:99], v[208:211], v[224:239]
  s_xor_b32 s53, s61, 53248
  buffer_load_dwordx4 v[200:203], v35, s[24:27], s53 offen offset:0 sc1
  buffer_load_dwordx4 v[204:207], v35, s[24:27], s53 offen offset:2048 sc1
  s_waitcnt lgkmcnt(0)
  s_barrier
  ds_read_b128 v[144:147], v11 offset:0
  ds_read_b128 v[148:151], v11 offset:1024
  v_mfma_f32_32x32x16_bf16 v[128:143], a[100:103], v[208:211], v[128:143]
  ds_read_b128 v[152:155], v11 offset:2048
  ds_read_b128 v[156:159], v11 offset:3072
  v_mfma_f32_32x32x16_bf16 v[224:239], a[104:107], v[212:215], v[224:239]
  s_waitcnt vmcnt(12)
  v_lshl_add_u64 v[216:217], v[216:217], 0, v[28:29]
  v_lshl_add_u64 v[220:221], v[220:221], 0, v[28:29]
  v_or3_b32 v41, v216, v217, v220
  v_bitop3_b32 v41, v41, v221, s81 bitop3:0xa8
  v_cmp_ne_u32 vcc, 0, v41
  v_mfma_f32_32x32x16_bf16 v[128:143], a[108:111], v[212:215], v[128:143]
  s_cbranch_vccnz L_sl40
L_sl40_b:
  v_mfma_f32_32x32x16_bf16 v[224:239], a[112:115], v[216:219], v[224:239]
  s_xor_b32 s53, s61, 57344
  buffer_load_dwordx4 v[208:211], v35, s[24:27], s53 offen offset:0 sc1
  buffer_load_dwordx4 v[212:215], v35, s[24:27], s53 offen offset:2048 sc1
  s_waitcnt lgkmcnt(3)
  v_add_f32 v112, v112, v144
  v_add_f32 v113, v113, v145
  v_add_f32 v114, v114, v146
  v_add_f32 v115, v115, v147
  v_mfma_f32_32x32x16_bf16 v[128:143], a[116:119], v[216:219], v[128:143]
  v_cvt_pk_bf16_f32 v112, v112, v113
  v_cvt_pk_bf16_f32 v113, v114, v115
  s_waitcnt lgkmcnt(2)
  v_add_f32 v116, v116, v148
  v_add_f32 v117, v117, v149
  v_add_f32 v118, v118, v150
  v_add_f32 v119, v119, v151
  v_mfma_f32_32x32x16_bf16 v[224:239], a[120:123], v[220:223], v[224:239]
  s_waitcnt vmcnt(12)
  v_lshl_add_u64 v[160:161], v[160:161], 0, v[28:29]
  v_lshl_add_u64 v[164:165], v[164:165], 0, v[28:29]
  v_or3_b32 v41, v160, v161, v164
  v_bitop3_b32 v41, v41, v165, s81 bitop3:0xa8
  v_cmp_ne_u32 vcc, 0, v41
  v_mfma_f32_32x32x16_bf16 v[128:143], a[124:127], v[220:223], v[128:143]
  v_lshl_add_u64 v[112:113], v[112:113], 0, v[60:61]
  v_cvt_pk_bf16_f32 v114, v116, v117
  v_cvt_pk_bf16_f32 v115, v118, v119
  s_cbranch_vccnz L_sl41
L_sl41_b:
  v_mfma_f32_32x32x16_bf16 v[224:239], a[128:131], v[160:163], v[224:239]
  s_xor_b32 s53, s61, 61440
  buffer_load_dwordx4 v[216:219], v35, s[24:27], s53 offen offset:0 sc1
  buffer_load_dwordx4 v[220:223], v35, s[24:27], s53 offen offset:2048 sc1
  s_waitcnt lgkmcnt(1)
  v_add_f32 v120, v120, v152
  v_add_f32 v121, v121, v153
  v_add_f32 v122, v122, v154
  v_add_f32 v123, v123, v155
  s_cmp_eq_u32 s47, 0
  s_cbranch_scc0 L_ss42
  buffer_store_dwordx4 v[112:115], v12, s[24:27], 0 offen offset:0
L_ss42_e:
  v_mfma_f32_32x32x16_bf16 v[128:143], a[132:135], v[160:163], v[128:143]
  v_cvt_pk_bf16_f32 v116, v120, v121
  v_cvt_pk_bf16_f32 v117, v122, v123
  s_waitcnt lgkmcnt(0)
  v_add_f32 v124, v124, v156
  v_add_f32 v125, v125, v157
  v_add_f32 v126, v126, v158
  v_add_f32 v127, v127, v159
  v_mfma_f32_32x32x16_bf16 v[224:239], a[136:139], v[164:167], v[224:239]
  s_waitcnt vmcnt(13)
  v_lshl_add_u64 v[168:169], v[168:169], 0, v[28:29]
  v_lshl_add_u64 v[172:173], v[172:173], 0, v[28:29]
  v_or3_b32 v41, v168, v169, v172
  v_bitop3_b32 v41, v41, v173, s81 bitop3:0xa8
  v_cmp_ne_u32 vcc, 0, v41
  v_mfma_f32_32x32x16_bf16 v[128:143], a[140:143], v[164:167], v[128:143]
  v_lshl_add_u64 v[116:117], v[116:117], 0, v[60:61]
  v_cvt_pk_bf16_f32 v118, v124, v125
  v_cvt_pk_bf16_f32 v119, v126, v127
  s_cbranch_vccnz L_sl43
L_sl43_b:
  v_mfma_f32_32x32x16_bf16 v[224:239], a[144:147], v[168:171], v[224:239]
  s_cmp_eq_u32 s47, 0
  s_cbranch_scc0 L_ss44
  buffer_store_dwordx4 v[116:119], v12, s[24:27], 0 offen offset:1024
L_ss44_e:
  v_mfma_f32_32x32x16_bf16 v[128:143], a[148:151], v[168:171], v[128:143]
  v_mfma_f32_32x32x16_bf16 v[224:239], a[152:155], v[172:175], v[224:239]
  s_waitcnt vmcnt(12)
  v_lshl_add_u64 v[176:177], v[176:177], 0, v[28:29]
  v_lshl_add_u64 v[180:181], v[180:181], 0, v[28:29]
  v_or3_b32 v41, v176, v177, v180
  v_bitop3_b32 v41, v41, v181, s81 bitop3:0xa8
  v_cmp_ne_u32 vcc, 0, v41
  v_mfma_f32_32x32x16_bf16 v[128:143], a[156:159], v[172:175], v[128:143]
  s_cbranch_vccnz L_sl45
L_sl45_b:
  v_mfma_f32_32x32x16_bf16 v[224:239], a[160:163], v[176:179], v[224:239]
  v_mfma_f32_32x32x16_bf16 v[128:143], a[164:167], v[176:179], v[128:143]
  v_mfma_f32_32x32x16_bf16 v[224:239], a[168:171], v[180:183], v[224:239]
  s_waitcnt vmcnt(10)
  v_lshl_add_u64 v[184:185], v[184:185], 0, v[28:29]
  v_lshl_add_u64 v[188:189], v[188:189], 0, v[28:29]
  v_or3_b32 v41, v184, v185, v188
  v_bitop3_b32 v41, v41, v189, s81 bitop3:0xa8
  v_cmp_ne_u32 vcc, 0, v41
  v_mfma_f32_32x32x16_bf16 v[128:143], a[172:175], v[180:183], v[128:143]
  s_cbranch_vccnz L_sl46
L_sl46_b:
  v_mfma_f32_32x32x16_bf16 v[224:239], a[176:179], v[184:187], v[224:239]
  v_mfma_f32_32x32x16_bf16 v[128:143], a[180:183], v[184:187], v[128:143]
  v_mfma_f32_32x32x16_bf16 v[224:239], a[184:187], v[188:191], v[224:239]
  s_waitcnt vmcnt(8)
  v_lshl_add_u64 v[192:193], v[192:193], 0, v[28:29]
  v_lshl_add_u64 v[196:197], v[196:197], 0, v[28:29]
  v_or3_b32 v41, v192, v193, v196
  v_bitop3_b32 v41, v41, v197, s81 bitop3:0xa8
  v_cmp_ne_u32 vcc, 0, v41
  v_mfma_f32_32x32x16_bf16 v[128:143], a[188:191], v[188:191], v[128:143]
  s_cbranch_vccnz L_sl47
L_sl47_b:
  v_mfma_f32_32x32x16_bf16 v[224:239], a[192:195], v[192:195], v[224:239]
  v_mfma_f32_32x32x16_bf16 v[128:143], a[196:199], v[192:195], v[128:143]
  v_mfma_f32_32x32x16_bf16 v[224:239], a[200:203], v[196:199], v[224:239]
  s_waitcnt vmcnt(6)
  v_lshl_add_u64 v[200:201], v[200:201], 0, v[28:29]
  v_lshl_add_u64 v[204:205], v[204:205], 0, v[28:29]
  v_or3_b32 v41, v200, v201, v204
  v_bitop3_b32 v41, v41, v205, s81 bitop3:0xa8
  v_cmp_ne_u32 vcc, 0, v41
  v_mfma_f32_32x32x16_bf16 v[128:143], a[204:207], v[196:199], v[128:143]
  s_cbranch_vccnz L_sl48
L_sl48_b:
  v_mfma_f32_32x32x16_bf16 v[224:239], a[208:211], v[200:203], v[224:239]
  v_mfma_f32_32x32x16_bf16 v[128:143], a[212:215], v[200:203], v[128:143]
  v_mfma_f32_32x32x16_bf16 v[224:239], a[216:219], v[204:207], v[224:239]
  s_waitcnt vmcnt(4)
  v_lshl_add_u64 v[208:209], v[208:209], 0, v[28:29]
  v_lshl_add_u64 v[212:213], v[212:213], 0, v[28:29]
  v_or3_b32 v41, v208, v209, v212
  v_bitop3_b32 v41, v41, v213, s81 bitop3:0xa8
  v_cmp_ne_u32 vcc, 0, v41
  v_mfma_f32_32x32x16_bf16 v[128:143], a[220:223], v[204:207], v[128:143]
  s_cbranch_vccnz L_sl49
L_sl49_b:
  v_mfma_f32_32x32x16_bf16 v[224:239], a[224:227], v[208:211], v[224:239]
  buffer_load_dwordx4 v[120:123], v13, s[24:27], 0 offen offset:0 sc1
  buffer_load_dwordx4 v[124:127], v13, s[24:27], 0 offen offset:1024 sc1
  v_mfma_f32_32x32x16_bf16 v[128:143], a[228:231], v[208:211], v[128:143]
  v_mfma_f32_32x32x16_bf16 v[224:239], a[232:235], v[212:215], v[224:239]
  s_waitcnt vmcnt(4)
  v_lshl_add_u64 v[216:217], v[216:217], 0, v[28:29]
  v_lshl_add_u64 v[220:221], v[220:221], 0, v[28:29]
  v_or3_b32 v41, v216, v217, v220
  v_bitop3_b32 v41, v41, v221, s81 bitop3:0xa8
  v_cmp_ne_u32 vcc, 0, v41
  v_mfma_f32_32x32x16_bf16 v[128:143], a[236:239], v[212:215], v[128:143]
  s_cbranch_vccnz L_sl50
L_sl50_b:
  v_mfma_f32_32x32x16_bf16 v[128:143], a[244:247], v[216:219], v[128:143]
  v_mfma_f32_32x32x16_bf16 v[128:143], a[252:255], v[220:223], v[128:143]
  v_mfma_f32_32x32x16_bf16 v[224:239], a[240:243], v[216:219], v[224:239]
  v_mfma_f32_32x32x16_bf16 v[224:239], a[248:251], v[220:223], v[224:239]
  s_lshr_b32 s53, s54, 16
  s_nop 8
  ds_write_b128 v11, v[128:131] offset:0
  ds_write_b128 v11, v[132:135] offset:1024
  ds_write_b128 v11, v[136:139] offset:2048
  ds_write_b128 v11, v[140:143] offset:3072
  v_pk_mul_f32 v[224:225], v[224:225], s[54:55]
  v_pk_mul_f32 v[226:227], v[226:227], s[54:55]
  v_pk_mul_f32 v[228:229], v[228:229], s[54:55]
  v_pk_mul_f32 v[230:231], v[230:231], s[54:55]
  v_pk_mul_f32 v[232:233], v[232:233], s[54:55]
  v_pk_mul_f32 v[234:235], v[234:235], s[54:55]
  v_pk_mul_f32 v[236:237], v[236:237], s[54:55]
  v_pk_mul_f32 v[238:239], v[238:239], s[54:55]
  s_waitcnt lgkmcnt(0)
  s_barrier
  ds_read_b128 v[160:163], v10 offset:0
  ds_read_b128 v[164:167], v10 offset:1024
  ds_read_b128 v[168:171], v10 offset:2048
  ds_read_b128 v[172:175], v10 offset:3072
  s_waitcnt vmcnt(0)
  v_lshl_add_u64 v[120:121], v[120:121], 0, v[62:63]
  v_lshl_add_u64 v[124:125], v[124:125], 0, v[62:63]
  v_or3_b32 v44, v120, v121, v124
  v_bitop3_b32 v44, v44, v125, s81 bitop3:0xa8
  v_cmp_ne_u32 vcc, 0, v44
  s_cbranch_vccnz L_sl51
L_sl51_b:
  v_dot2c_f32_bf16 v224, s53, v120
  v_dot2c_f32_bf16 v225, s54, v120
  v_dot2c_f32_bf16 v226, s53, v121
  v_dot2c_f32_bf16 v227, s54, v121
  v_dot2c_f32_bf16 v228, s53, v122
  v_dot2c_f32_bf16 v229, s54, v122
  v_dot2c_f32_bf16 v230, s53, v123
  v_dot2c_f32_bf16 v231, s54, v123
  v_dot2c_f32_bf16 v232, s53, v124
  v_dot2c_f32_bf16 v233, s54, v124
  v_dot2c_f32_bf16 v234, s53, v125
  v_dot2c_f32_bf16 v235, s54, v125
  v_dot2c_f32_bf16 v236, s53, v126
  v_dot2c_f32_bf16 v237, s54, v126
  v_dot2c_f32_bf16 v238, s53, v127
  v_dot2c_f32_bf16 v239, s54, v127
  s_waitcnt lgkmcnt(3)
  v_pk_fma_f32 v[224:225], v[160:161], s[54:55], v[224:225]
  v_pk_fma_f32 v[226:227], v[162:163], s[54:55], v[226:227]
  s_waitcnt lgkmcnt(2)
  v_pk_fma_f32 v[228:229], v[164:165], s[54:55], v[228:229]
  v_pk_fma_f32 v[230:231], v[166:167], s[54:55], v[230:231]
  s_waitcnt lgkmcnt(1)
  v_pk_fma_f32 v[232:233], v[168:169], s[54:55], v[232:233]
  v_pk_fma_f32 v[234:235], v[170:171], s[54:55], v[234:235]
  s_waitcnt lgkmcnt(0)
  v_pk_fma_f32 v[236:237], v[172:173], s[54:55], v[236:237]
  v_pk_fma_f32 v[238:239], v[174:175], s[54:55], v[238:239]
  s_add_u32 m0, s44, 114688
  s_mov_b32 s45, 0
  buffer_load_dwordx4 v72, s[20:23], s45 offen offset:0 lds
  v_pk_mul_f32 v[208:209], v[224:225], v[224:225]
  v_pk_mul_f32 v[210:211], v[226:227], v[226:227]
  v_pk_mul_f32 v[212:213], v[228:229], v[228:229]
  v_pk_mul_f32 v[214:215], v[230:231], v[230:231]
  v_pk_mul_f32 v[216:217], v[232:233], v[232:233]
  v_pk_mul_f32 v[218:219], v[234:235], v[234:235]
  v_pk_mul_f32 v[220:221], v[236:237], v[236:237]
  v_pk_mul_f32 v[222:223], v[238:239], v[238:239]
  v_pk_fma_f32 v[208:209], v[208:209], v[42:43], v[42:43] op_sel:[0,1,0] op_sel_hi:[1,1,0]
  v_pk_fma_f32 v[210:211], v[210:211], v[42:43], v[42:43] op_sel:[0,1,0] op_sel_hi:[1,1,0]
  v_pk_fma_f32 v[212:213], v[212:213], v[42:43], v[42:43] op_sel:[0,1,0] op_sel_hi:[1,1,0]
  v_pk_fma_f32 v[214:215], v[214:215], v[42:43], v[42:43] op_sel:[0,1,0] op_sel_hi:[1,1,0]
  buffer_load_dwordx4 v73, s[20:23], s45 offen offset:1024 lds
  v_pk_fma_f32 v[216:217], v[216:217], v[42:43], v[42:43] op_sel:[0,1,0] op_sel_hi:[1,1,0]
  v_pk_fma_f32 v[218:219], v[218:219], v[42:43], v[42:43] op_sel:[0,1,0] op_sel_hi:[1,1,0]
  v_pk_fma_f32 v[220:221], v[220:221], v[42:43], v[42:43] op_sel:[0,1,0] op_sel_hi:[1,1,0]
  v_pk_fma_f32 v[222:223], v[222:223], v[42:43], v[42:43] op_sel:[0,1,0] op_sel_hi:[1,1,0]
  v_pk_mul_f32 v[208:209], v[208:209], v[224:225]
  v_pk_mul_f32 v[210:211], v[210:211], v[226:227]
  v_pk_mul_f32 v[212:213], v[212:213], v[228:229]
  v_pk_mul_f32 v[214:215], v[214:215], v[230:231]
  v_pk_mul_f32 v[216:217], v[216:217], v[232:233]
  v_pk_mul_f32 v[218:219], v[218:219], v[234:235]
  v_pk_mul_f32 v[220:221], v[220:221], v[236:237]
  v_pk_mul_f32 v[222:223], v[222:223], v[238:239]
  buffer_load_dwordx4 v74, s[20:23], s45 offen offset:2048 lds
  v_exp_f32 v208, v208
  v_exp_f32 v209, v209
  v_exp_f32 v210, v210
  buffer_load_dwordx4 v75, s[20:23], s45 offen offset:3072 lds
  v_exp_f32 v211, v211
  v_exp_f32 v212, v212
  v_exp_f32 v213, v213
  s_add_u32 m0, s44, 65536
  s_mov_b32 s45, 262144
  buffer_load_dwordx4 v72, s[20:23], s45 offen offset:0 lds
  v_exp_f32 v214, v214
  v_exp_f32 v215, v215
  v_pk_fma_f32 v[208:209], v[208:209], s[54:55], s[54:55]
  v_pk_fma_f32 v[210:211], v[210:211], s[54:55], s[54:55]
  v_pk_fma_f32 v[212:213], v[212:213], s[54:55], s[54:55]
  v_pk_fma_f32 v[214:215], v[214:215], s[54:55], s[54:55]
  buffer_load_dwordx4 v73, s[20:23], s45 offen offset:1024 lds
  v_rcp_f32 v208, v208
  v_rcp_f32 v209, v209
  v_rcp_f32 v210, v210
  buffer_load_dwordx4 v74, s[20:23], s45 offen offset:2048 lds
  v_rcp_f32 v211, v211
  v_rcp_f32 v212, v212
  v_rcp_f32 v213, v213
  buffer_load_dwordx4 v75, s[20:23], s45 offen offset:3072 lds
  v_rcp_f32 v214, v214
  v_rcp_f32 v215, v215
  v_pk_mul_f32 v[208:209], v[208:209], v[224:225]
  v_pk_mul_f32 v[210:211], v[210:211], v[226:227]
  v_pk_mul_f32 v[212:213], v[212:213], v[228:229]
  v_pk_mul_f32 v[214:215], v[214:215], v[230:231]
  s_add_u32 m0, s44, 81920
  s_mov_b32 s45, 524288
  buffer_load_dwordx4 v72, s[20:23], s45 offen offset:0 lds
  v_cvt_pk_bf16_f32 v56, v208, v209
  v_cvt_pk_bf16_f32 v57, v210, v211
  v_cvt_pk_bf16_f32 v58, v212, v213
  v_cvt_pk_bf16_f32 v59, v214, v215
  v_lshl_add_u64 v[56:57], v[56:57], 0, v[26:27]
  buffer_store_dwordx4 v[56:59], v40, s[24:27], 0 offen offset:0 sc1
  v_exp_f32 v216, v216
  v_exp_f32 v217, v217
  v_exp_f32 v218, v218
  v_exp_f32 v219, v219
  v_exp_f32 v220, v220
  v_exp_f32 v221, v221
  v_exp_f32 v222, v222
  v_exp_f32 v223, v223
  v_pk_fma_f32 v[216:217], v[216:217], s[54:55], s[54:55]
  v_pk_fma_f32 v[218:219], v[218:219], s[54:55], s[54:55]
  v_pk_fma_f32 v[220:221], v[220:221], s[54:55], s[54:55]
  v_pk_fma_f32 v[222:223], v[222:223], s[54:55], s[54:55]
  v_rcp_f32 v216, v216
  v_rcp_f32 v217, v217
  v_rcp_f32 v218, v218
  v_rcp_f32 v219, v219
  v_rcp_f32 v220, v220
  v_rcp_f32 v221, v221
  v_rcp_f32 v222, v222
  v_rcp_f32 v223, v223
  v_pk_mul_f32 v[216:217], v[216:217], v[232:233]
  v_pk_mul_f32 v[218:219], v[218:219], v[234:235]
  v_pk_mul_f32 v[220:221], v[220:221], v[236:237]
  v_pk_mul_f32 v[222:223], v[222:223], v[238:239]
  v_cvt_pk_bf16_f32 v60, v216, v217
  v_cvt_pk_bf16_f32 v61, v218, v219
  v_cvt_pk_bf16_f32 v62, v220, v221
  v_cvt_pk_bf16_f32 v63, v222, v223
  v_lshl_add_u64 v[60:61], v[60:61], 0, v[26:27]
  buffer_store_dwordx4 v[60:63], v40, s[24:27], 0 offen offset:2048 sc1
  buffer_load_dwordx4 v73, s[20:23], s45 offen offset:1024 lds
  buffer_load_dwordx4 v74, s[20:23], s45 offen offset:2048 lds
  buffer_load_dwordx4 v75, s[20:23], s45 offen offset:3072 lds
  s_and_b32 s41, s2, 7
  s_lshl_b32 s41, s41, 7
  s_add_u32 s41, s41, 6816768
  s_cmp_lt_u32 s2, 8
  s_cselect_b32 s41, s41, 8388608
  v_lshl_add_u32 v3, v0, 23, s41
  v_mov_b32 v4, s46
  buffer_store_dword v4, v3, s[24:27], 0 offen
  s_add_u32 m0, s44, 131072
  s_mov_b32 s45, 786432
  buffer_load_dwordx4 v72, s[20:23], s45 offen offset:0 lds
  buffer_load_dwordx4 v73, s[20:23], s45 offen offset:1024 lds
  buffer_load_dwordx4 v74, s[20:23], s45 offen offset:2048 lds
  buffer_load_dwordx4 v75, s[20:23], s45 offen offset:3072 lds
  s_add_u32 m0, s44, 147456
  s_mov_b32 s45, 1048576
  buffer_load_dwordx4 v72, s[20:23], s45 offen offset:0 lds
  buffer_load_dwordx4 v73, s[20:23], s45 offen offset:1024 lds
  buffer_load_dwordx4 v74, s[20:23], s45 offen offset:2048 lds
  buffer_load_dwordx4 v75, s[20:23], s45 offen offset:3072 lds
  s_add_u32 m0, s44, 16384
  s_mov_b32 s45, 1310720
  buffer_load_dwordx4 v72, s[20:23], s45 offen offset:0 lds
  buffer_load_dwordx4 v73, s[20:23], s45 offen offset:1024 lds
  buffer_load_dwordx4 v74, s[20:23], s45 offen offset:2048 lds
  buffer_load_dwordx4 v75, s[20:23], s45 offen offset:3072 lds
  s_add_u32 m0, s44, 32768
  s_mov_b32 s45, 1572864
  buffer_load_dwordx4 v72, s[20:23], s45 offen offset:0 lds
  buffer_load_dwordx4 v73, s[20:23], s45 offen offset:1024 lds
  buffer_load_dwordx4 v74, s[20:23], s45 offen offset:2048 lds
  buffer_load_dwordx4 v75, s[20:23], s45 offen offset:3072 lds
  s_waitcnt vmcnt(27)
  s_waitcnt vmcnt(23)
  s_barrier
  ds_read_b64_tr_b16 a[0:1], v21 offset:49152
  ds_read_b64_tr_b16 a[2:3], v21 offset:50176
  ds_read_b64_tr_b16 a[4:5], v22 offset:49152
  ds_read_b64_tr_b16 a[6:7], v22 offset:50176
  ds_read_b64_tr_b16 a[8:9], v21 offset:51200
  ds_read_b64_tr_b16 a[10:11], v21 offset:52224
  ds_read_b64_tr_b16 a[12:13], v22 offset:51200
  ds_read_b64_tr_b16 a[14:15], v22 offset:52224
  ds_read_b64_tr_b16 a[16:17], v47 offset:49152
  ds_read_b64_tr_b16 a[18:19], v47 offset:50176
  ds_read_b64_tr_b16 a[20:21], v68 offset:49152
  ds_read_b64_tr_b16 a[22:23], v68 offset:50176
  ds_read_b64_tr_b16 a[24:25], v47 offset:51200
  ds_read_b64_tr_b16 a[26:27], v47 offset:52224
  ds_read_b64_tr_b16 a[28:29], v68 offset:51200
  ds_read_b64_tr_b16 a[30:31], v68 offset:52224
L_join:
  s_waitcnt lgkmcnt(0)
  buffer_load_dwordx2 v[56:57], v31, s[24:27], 0 offen sc1
  s_xor_b32 s53, s49, 0
  buffer_load_dwordx4 v[176:179], v30, s[24:27], s53 offen offset:0 sc1
  buffer_load_dwordx4 v[180:183], v30, s[24:27], s53 offen offset:2048 sc1
  s_xor_b32 s53, s49, 4096
  buffer_load_dwordx4 v[184:187], v30, s[24:27], s53 offen offset:0 sc1
  buffer_load_dwordx4 v[188:191], v30, s[24:27], s53 offen offset:2048 sc1
  s_xor_b32 s53, s49, 8192
  buffer_load_dwordx4 v[192:195], v30, s[24:27], s53 offen offset:0 sc1
  buffer_load_dwordx4 v[196:199], v30, s[24:27], s53 offen offset:2048 sc1
  s_xor_b32 s53, s49, 12288
  buffer_load_dwordx4 v[200:203], v30, s[24:27], s53 offen offset:0 sc1
  buffer_load_dwordx4 v[204:207], v30, s[24:27], s53 offen offset:2048 sc1
  v_xor_b32 v60, 0x40000000, v26
  v_xor_b32 v61, 536870912, v27
  v_not_b32 v62, v60
  v_not_b32 v63, v61
  v_lshl_add_u64 v[62:63], v[62:63], 0, 1
  s_waitcnt vmcnt(8)
  v_lshl_add_u64 v[56:57], v[56:57], 0, v[28:29]
  v_bitop3_b32 v15, v56, v57, s81 bitop3:0xa8
  v_cmp_ne_u32 vcc, 0, v15
  s_cbranch_vccnz L_p4p52
L_p4p52_b:
  s_xor_b32 s53, s49, 16384
  buffer_load_dwordx4 v[208:211], v30, s[24:27], s53 offen offset:0 sc1
  buffer_load_dwordx4 v[212:215], v30, s[24:27], s53 offen offset:2048 sc1
  s_xor_b32 s53, s49, 20480
  buffer_load_dwordx4 v[216:219], v30, s[24:27], s53 offen offset:0 sc1
  buffer_load_dwordx4 v[220:223], v30, s[24:27], s53 offen offset:2048 sc1
  s_xor_b32 s53, s49, 24576
  buffer_load_dwordx4 v[224:227], v30, s[24:27], s53 offen offset:0 sc1
  buffer_load_dwordx4 v[228:231], v30, s[24:27], s53 offen offset:2048 sc1
  s_waitcnt vmcnt(12)
  v_lshl_add_u64 v[176:177], v[176:177], 0, v[28:29]
  v_lshl_add_u64 v[180:181], v[180:181], 0, v[28:29]
  v_or3_b32 v15, v176, v177, v180
  v_bitop3_b32 v15, v15, v181, s81 bitop3:0xa8
  v_cmp_ne_u32 vcc, 0, v15
  s_cbranch_vccnz L_sl53
L_sl53_b:
  v_mfma_f32_32x32x16_bf16 v[128:143], v[176:179], a[0:3], 0
  s_xor_b32 s53, s49, 28672
  buffer_load_dwordx4 v[232:235], v30, s[24:27], s53 offen offset:0 sc1
  buffer_load_dwordx4 v[236:239], v30, s[24:27], s53 offen offset:2048 sc1
  s_barrier
  v_mfma_f32_32x32x16_bf16 v[160:175], v[176:179], a[4:7], 0
  ds_read_b64_tr_b16 a[32:33], v21 offset:0
  ds_read_b64_tr_b16 a[34:35], v21 offset:1024
  ds_read_b64_tr_b16 a[36:37], v22 offset:0
  ds_read_b64_tr_b16 a[38:39], v22 offset:1024
  v_mfma_f32_32x32x16_bf16 v[128:143], v[180:183], a[8:11], v[128:143]
  s_waitcnt vmcnt(12)
  v_lshl_add_u64 v[184:185], v[184:185], 0, v[28:29]
  v_lshl_add_u64 v[188:189], v[188:189], 0, v[28:29]
  v_or3_b32 v15, v184, v185, v188
  v_bitop3_b32 v15, v15, v189, s81 bitop3:0xa8
  v_cmp_ne_u32 vcc, 0, v15
  v_mfma_f32_32x32x16_bf16 v[160:175], v[180:183], a[12:15], v[160:175]
  ds_read_b64_tr_b16 a[40:41], v21 offset:2048
  ds_read_b64_tr_b16 a[42:43], v21 offset:3072
  ds_read_b64_tr_b16 a[44:45], v22 offset:2048
  ds_read_b64_tr_b16 a[46:47], v22 offset:3072
  s_cbranch_vccnz L_sl54
L_sl54_b:
  v_mfma_f32_32x32x16_bf16 v[128:143], v[184:187], a[16:19], v[128:143]
  s_xor_b32 s53, s49, 32768
  buffer_load_dwordx4 v[176:179], v30, s[24:27], s53 offen offset:0 sc1
  buffer_load_dwordx4 v[180:183], v30, s[24:27], s53 offen offset:2048 sc1
  v_mfma_f32_32x32x16_bf16 v[160:175], v[184:187], a[20:23], v[160:175]
  ds_read_b64_tr_b16 a[48:49], v47 offset:0
  ds_read_b64_tr_b16 a[50:51], v47 offset:1024
  ds_read_b64_tr_b16 a[52:53], v68 offset:0
  ds_read_b64_tr_b16 a[54:55], v68 offset:1024
  v_mfma_f32_32x32x16_bf16 v[128:143], v[188:191], a[24:27], v[128:143]
  s_waitcnt vmcnt(12)
  v_lshl_add_u64 v[192:193], v[192:193], 0, v[28:29]
  v_lshl_add_u64 v[196:197], v[196:197], 0, v[28:29]
  v_or3_b32 v15, v192, v193, v196
  v_bitop3_b32 v15, v15, v197, s81 bitop3:0xa8
  v_cmp_ne_u32 vcc, 0, v15
  v_mfma_f32_32x32x16_bf16 v[160:175], v[188:191], a[28:31], v[160:175]
  ds_read_b64_tr_b16 a[56:57], v47 offset:2048
  ds_read_b64_tr_b16 a[58:59], v47 offset:3072
  ds_read_b64_tr_b16 a[60:61], v68 offset:2048
  ds_read_b64_tr_b16 a[62:63], v68 offset:3072
  s_cbranch_vccnz L_sl55
L_sl55_b:
  s_waitcnt lgkmcnt(8)
  v_mfma_f32_32x32x16_bf16 v[128:143], v[192:195], a[32:35], v[128:143]
  s_xor_b32 s53, s49, 36864
  buffer_load_dwordx4 v[184:187], v30, s[24:27], s53 offen offset:0 sc1
  buffer_load_dwordx4 v[188:191], v30, s[24:27], s53 offen offset:2048 sc1
  v_mfma_f32_32x32x16_bf16 v[160:175], v[192:195], a[36:39], v[160:175]
  ds_read_b64_tr_b16 a[64:65], v21 offset:16384
  ds_read_b64_tr_b16 a[66:67], v21 offset:17408
  ds_read_b64_tr_b16 a[68:69], v22 offset:16384
  ds_read_b64_tr_b16 a[70:71], v22 offset:17408
  v_mfma_f32_32x32x16_bf16 v[128:143], v[196:199], a[40:43], v[128:143]
  s_waitcnt vmcnt(12)
  v_lshl_add_u64 v[200:201], v[200:201], 0, v[28:29]
  v_lshl_add_u64 v[204:205], v[204:205], 0, v[28:29]
  v_or3_b32 v15, v200, v201, v204
  v_bitop3_b32 v15, v15, v205, s81 bitop3:0xa8
  v_cmp_ne_u32 vcc, 0, v15
  v_mfma_f32_32x32x16_bf16 v[160:175], v[196:199], a[44:47], v[160:175]
  ds_read_b64_tr_b16 a[72:73], v21 offset:18432
  ds_read_b64_tr_b16 a[74:75], v21 offset:19456
  ds_read_b64_tr_b16 a[76:77], v22 offset:18432
  ds_read_b64_tr_b16 a[78:79], v22 offset:19456
  s_cbranch_vccnz L_sl56
L_sl56_b:
  s_waitcnt lgkmcnt(8)
  v_mfma_f32_32x32x16_bf16 v[128:143], v[200:203], a[48:51], v[128:143]
  s_xor_b32 s53, s49, 40960
  buffer_load_dwordx4 v[192:195], v30, s[24:27], s53 offen offset:0 sc1
  buffer_load_dwordx4 v[196:199], v30, s[24:27], s53 offen offset:2048 sc1
  v_mfma_f32_32x32x16_bf16 v[160:175], v[200:203], a[52:55], v[160:175]
  ds_read_b64_tr_b16 a[80:81], v47 offset:16384
  ds_read_b64_tr_b16 a[82:83], v47 offset:17408
  ds_read_b64_tr_b16 a[84:85], v68 offset:16384
  ds_read_b64_tr_b16 a[86:87], v68 offset:17408
  v_mfma_f32_32x32x16_bf16 v[128:143], v[204:207], a[56:59], v[128:143]
  s_waitcnt vmcnt(12)
  v_lshl_add_u64 v[208:209], v[208:209], 0, v[28:29]
  v_lshl_add_u64 v[212:213], v[212:213], 0, v[28:29]
  v_or3_b32 v15, v208, v209, v212
  v_bitop3_b32 v15, v15, v213, s81 bitop3:0xa8
  v_cmp_ne_u32 vcc, 0, v15
  v_mfma_f32_32x32x16_bf16 v[160:175], v[204:207], a[60:63], v[160:175]
  ds_read_b64_tr_b16 a[88:89], v47 offset:18432
  ds_read_b64_tr_b16 a[90:91], v47 offset:19456
  ds_read_b64_tr_b16 a[92:93], v68 offset:18432
  ds_read_b64_tr_b16 a[94:95], v68 offset:19456
  s_cbranch_vccnz L_sl57
L_sl57_b:
  s_waitcnt lgkmcnt(8)
  v_mfma_f32_32x32x16_bf16 v[128:143], v[208:211], a[64:67], v[128:143]
  s_xor_b32 s53, s49, 45056
  buffer_load_dwordx4 v[200:203], v30, s[24:27], s53 offen offset:0 sc1
  buffer_load_dwordx4 v[204:207], v30, s[24:27], s53 offen offset:2048 sc1
  v_mfma_f32_32x32x16_bf16 v[160:175], v[208:211], a[68:71], v[160:175]
  ds_read_b64_tr_b16 a[96:97], v23 offset:0
  ds_read_b64_tr_b16 a[98:99], v23 offset:1024
  ds_read_b64_tr_b16 a[100:101], v24 offset:0
  ds_read_b64_tr_b16 a[102:103], v24 offset:1024
  v_mfma_f32_32x32x16_bf16 v[128:143], v[212:215], a[72:75], v[128:143]
  s_waitcnt vmcnt(12)
  v_lshl_add_u64 v[216:217], v[216:217], 0, v[28:29]
  v_lshl_add_u64 v[220:221], v[220:221], 0, v[28:29]
  v_or3_b32 v15, v216, v217, v220
  v_bitop3_b32 v15, v15, v221, s81 bitop3:0xa8
  v_cmp_ne_u32 vcc, 0, v15
  v_mfma_f32_32x32x16_bf16 v[160:175], v[212:215], a[76:79], v[160:175]
  ds_read_b64_tr_b16 a[104:105], v23 offset:2048
  ds_read_b64_tr_b16 a[106:107], v23 offset:3072
  ds_read_b64_tr_b16 a[108:109], v24 offset:2048
  ds_read_b64_tr_b16 a[110:111], v24 offset:3072
  s_cbranch_vccnz L_sl58
L_sl58_b:
  s_waitcnt lgkmcnt(8)
  v_mfma_f32_32x32x16_bf16 v[128:143], v[216:219], a[80:83], v[128:143]
  s_xor_b32 s53, s49, 0
  buffer_load_dwordx4 v[208:211], v14, s[24:27], s53 offen offset:0 sc1
  buffer_load_dwordx4 v[212:215], v14, s[24:27], s53 offen offset:2048 sc1
  v_mfma_f32_32x32x16_bf16 v[160:175], v[216:219], a[84:87], v[160:175]
  ds_read_b64_tr_b16 a[112:113], v69 offset:0
  ds_read_b64_tr_b16 a[114:115], v69 offset:1024
  ds_read_b64_tr_b16 a[116:117], v70 offset:0
  ds_read_b64_tr_b16 a[118:119], v70 offset:1024
  v_mfma_f32_32x32x16_bf16 v[128:143], v[220:223], a[88:91], v[128:143]
  s_waitcnt vmcnt(12)
  v_lshl_add_u64 v[224:225], v[224:225], 0, v[28:29]
  v_lshl_add_u64 v[228:229], v[228:229], 0, v[28:29]
  v_or3_b32 v15, v224, v225, v228
  v_bitop3_b32 v15, v15, v229, s81 bitop3:0xa8
  v_cmp_ne_u32 vcc, 0, v15
  v_mfma_f32_32x32x16_bf16 v[160:175], v[220:223], a[92:95], v[160:175]
  ds_read_b64_tr_b16 a[120:121], v69 offset:2048
  ds_read_b64_tr_b16 a[122:123], v69 offset:3072
  ds_read_b64_tr_b16 a[124:125], v70 offset:2048
  ds_read_b64_tr_b16 a[126:127], v70 offset:3072
  s_cbranch_vccnz L_sl59
L_sl59_b:
  s_waitcnt lgkmcnt(8)
  v_mfma_f32_32x32x16_bf16 v[128:143], v[224:227], a[96:99], v[128:143]
  s_xor_b32 s53, s49, 49152
  buffer_load_dwordx4 v[216:219], v30, s[24:27], s53 offen offset:0 sc1
  buffer_load_dwordx4 v[220:223], v30, s[24:27], s53 offen offset:2048 sc1
  v_mfma_f32_32x32x16_bf16 v[160:175], v[224:227], a[100:103], v[160:175]
  ds_read_b64_tr_b16 a[128:129], v23 offset:16384
  ds_read_b64_tr_b16 a[130:131], v23 offset:17408
  ds_read_b64_tr_b16 a[132:133], v24 offset:16384
  ds_read_b64_tr_b16 a[134:135], v24 offset:17408
  v_mfma_f32_32x32x16_bf16 v[128:143], v[228:231], a[104:107], v[128:143]
  s_waitcnt vmcnt(12)
  v_lshl_add_u64 v[232:233], v[232:233], 0, v[28:29]
  v_lshl_add_u64 v[236:237], v[236:237], 0, v[28:29]
  v_or3_b32 v15, v232, v233, v236
  v_bitop3_b32 v15, v15, v237, s81 bitop3:0xa8
  v_cmp_ne_u32 vcc, 0, v15
  v_mfma_f32_32x32x16_bf16 v[160:175], v[228:231], a[108:111], v[160:175]
  ds_read_b64_tr_b16 a[136:137], v23 offset:18432
  ds_read_b64_tr_b16 a[138:139], v23 offset:19456
  ds_read_b64_tr_b16 a[140:141], v24 offset:18432
  ds_read_b64_tr_b16 a[142:143], v24 offset:19456
  s_cbranch_vccnz L_sl60
L_sl60_b:
  s_waitcnt lgkmcnt(8)
  v_mfma_f32_32x32x16_bf16 v[128:143], v[232:235], a[112:115], v[128:143]
  s_xor_b32 s53, s49, 4096
  buffer_load_dwordx4 v[224:227], v14, s[24:27], s53 offen offset:0 sc1
  buffer_load_dwordx4 v[228:231], v14, s[24:27], s53 offen offset:2048 sc1
  v_mfma_f32_32x32x16_bf16 v[160:175], v[232:235], a[116:119], v[160:175]
  ds_read_b64_tr_b16 a[144:145], v69 offset:16384
  ds_read_b64_tr_b16 a[146:147], v69 offset:17408
  ds_read_b64_tr_b16 a[148:149], v70 offset:16384
  ds_read_b64_tr_b16 a[150:151], v70 offset:17408
  v_mfma_f32_32x32x16_bf16 v[128:143], v[236:239], a[120:123], v[128:143]
  s_waitcnt vmcnt(12)
  v_lshl_add_u64 v[176:177], v[176:177], 0, v[28:29]
  v_lshl_add_u64 v[180:181], v[180:181], 0, v[28:29]
  v_or3_b32 v15, v176, v177, v180
  v_bitop3_b32 v15, v15, v181, s81 bitop3:0xa8
  v_cmp_ne_u32 vcc, 0, v15
  v_mfma_f32_32x32x16_bf16 v[160:175], v[236:239], a[124:127], v[160:175]
  ds_read_b64_tr_b16 a[152:153], v69 offset:18432
  ds_read_b64_tr_b16 a[154:155], v69 offset:19456
  ds_read_b64_tr_b16 a[156:157], v70 offset:18432
  ds_read_b64_tr_b16 a[158:159], v70 offset:19456
  s_cbranch_vccnz L_sl61
L_sl61_b:
  s_waitcnt lgkmcnt(8)
  v_mfma_f32_32x32x16_bf16 v[128:143], v[176:179], a[128:131], v[128:143]
  s_xor_b32 s53, s49, 53248
  buffer_load_dwordx4 v[232:235], v30, s[24:27], s53 offen offset:0 sc1
  buffer_load_dwordx4 v[236:239], v30, s[24:27], s53 offen offset:2048 sc1
  v_mfma_f32_32x32x16_bf16 v[160:175], v[176:179], a[132:135], v[160:175]
  ds_read_b64_tr_b16 a[160:161], v19 offset:16384
  ds_read_b64_tr_b16 a[162:163], v19 offset:17408
  ds_read_b64_tr_b16 a[164:165], v20 offset:16384
  ds_read_b64_tr_b16 a[166:167], v20 offset:17408
  v_mfma_f32_32x32x16_bf16 v[128:143], v[180:183], a[136:139], v[128:143]
  s_waitcnt vmcnt(12)
  v_lshl_add_u64 v[184:185], v[184:185], 0, v[28:29]
  v_lshl_add_u64 v[188:189], v[188:189], 0, v[28:29]
  v_or3_b32 v15, v184, v185, v188
  v_bitop3_b32 v15, v15, v189, s81 bitop3:0xa8
  v_cmp_ne_u32 vcc, 0, v15
  v_mfma_f32_32x32x16_bf16 v[160:175], v[180:183], a[140:143], v[160:175]
  ds_read_b64_tr_b16 a[168:169], v19 offset:18432
  ds_read_b64_tr_b16 a[170:171], v19 offset:19456
  ds_read_b64_tr_b16 a[172:173], v20 offset:18432
  ds_read_b64_tr_b16 a[174:175], v20 offset:19456
  s_cbranch_vccnz L_sl62
L_sl62_b:
  s_waitcnt lgkmcnt(8)
  v_mfma_f32_32x32x16_bf16 v[128:143], v[184:187], a[144:147], v[128:143]
  s_xor_b32 s53, s49, 8192
  buffer_load_dwordx4 v[176:179], v14, s[24:27], s53 offen offset:0 sc1
  buffer_load_dwordx4 v[180:183], v14, s[24:27], s53 offen offset:2048 sc1
  v_mfma_f32_32x32x16_bf16 v[160:175], v[184:187], a[148:151], v[160:175]
  ds_read_b64_tr_b16 a[176:177], v25 offset:16384
  ds_read_b64_tr_b16 a[178:179], v25 offset:17408
  ds_read_b64_tr_b16 a[180:181], v32 offset:16384
  ds_read_b64_tr_b16 a[182:183], v32 offset:17408
  v_mfma_f32_32x32x16_bf16 v[128:143], v[188:191], a[152:155], v[128:143]
  s_waitcnt vmcnt(12)
  v_lshl_add_u64 v[192:193], v[192:193], 0, v[28:29]
  v_lshl_add_u64 v[196:197], v[196:197], 0, v[28:29]
  v_or3_b32 v15, v192, v193, v196
  v_bitop3_b32 v15, v15, v197, s81 bitop3:0xa8
  v_cmp_ne_u32 vcc, 0, v15
  v_mfma_f32_32x32x16_bf16 v[160:175], v[188:191], a[156:159], v[160:175]
  ds_read_b64_tr_b16 a[184:185], v25 offset:18432
  ds_read_b64_tr_b16 a[186:187], v25 offset:19456
  ds_read_b64_tr_b16 a[188:189], v32 offset:18432
  ds_read_b64_tr_b16 a[190:191], v32 offset:19456
  s_cbranch_vccnz L_sl63
L_sl63_b:
  s_waitcnt lgkmcnt(8)
  v_mfma_f32_32x32x16_bf16 v[128:143], v[192:195], a[160:163], v[128:143]
  s_xor_b32 s53, s49, 12288
  buffer_load_dwordx4 v[184:187], v14, s[24:27], s53 offen offset:0 sc1
  buffer_load_dwordx4 v[188:191], v14, s[24:27], s53 offen offset:2048 sc1
  v_mfma_f32_32x32x16_bf16 v[160:175], v[192:195], a[164:167], v[160:175]
  ds_read_b64_tr_b16 a[192:193], v19 offset:32768
  ds_read_b64_tr_b16 a[194:195], v19 offset:33792
  ds_read_b64_tr_b16 a[196:197], v20 offset:32768
  ds_read_b64_tr_b16 a[198:199], v20 offset:33792
  v_mfma_f32_32x32x16_bf16 v[128:143], v[196:199], a[168:171], v[128:143]
  s_waitcnt vmcnt(12)
  v_lshl_add_u64 v[200:201], v[200:201], 0, v[28:29]
  v_lshl_add_u64 v[204:205], v[204:205], 0, v[28:29]
  v_or3_b32 v15, v200, v201, v204
  v_bitop3_b32 v15, v15, v205, s81 bitop3:0xa8
  v_cmp_ne_u32 vcc, 0, v15
  v_mfma_f32_32x32x16_bf16 v[160:175], v[196:199], a[172:175], v[160:175]
  ds_read_b64_tr_b16 a[200:201], v19 offset:34816
  ds_read_b64_tr_b16 a[202:203], v19 offset:35840
  ds_read_b64_tr_b16 a[204:205], v20 offset:34816
  ds_read_b64_tr_b16 a[206:207], v20 offset:35840
  s_cbranch_vccnz L_sl64
L_sl64_b:
  s_waitcnt lgkmcnt(8)
  v_mfma_f32_32x32x16_bf16 v[128:143], v[200:203], a[176:179], v[128:143]
  s_xor_b32 s53, s49, 16384
  buffer_load_dwordx4 v[192:195], v14, s[24:27], s53 offen offset:0 sc1
  buffer_load_dwordx4 v[196:199], v14, s[24:27], s53 offen offset:2048 sc1
  v_mfma_f32_32x32x16_bf16 v[160:175], v[200:203], a[180:183], v[160:175]
  ds_read_b64_tr_b16 a[208:209], v25 offset:32768
  ds_read_b64_tr_b16 a[210:211], v25 offset:33792
  ds_read_b64_tr_b16 a[212:213], v32 offset:32768
  ds_read_b64_tr_b16 a[214:215], v32 offset:33792
  v_mfma_f32_32x32x16_bf16 v[128:143], v[204:207], a[184:187], v[128:143]
  s_waitcnt vmcnt(12)
  v_lshl_add_u64 v[208:209], v[208:209], 0, v[28:29]
  v_lshl_add_u64 v[212:213], v[212:213], 0, v[28:29]
  v_or3_b32 v15, v208, v209, v212
  v_bitop3_b32 v15, v15, v213, s81 bitop3:0xa8
  v_cmp_ne_u32 vcc, 0, v15
  v_mfma_f32_32x32x16_bf16 v[160:175], v[204:207], a[188:191], v[160:175]
  ds_read_b64_tr_b16 a[216:217], v25 offset:34816
  ds_read_b64_tr_b16 a[218:219], v25 offset:35840
  ds_read_b64_tr_b16 a[220:221], v32 offset:34816
  ds_read_b64_tr_b16 a[222:223], v32 offset:35840
  s_cbranch_vccnz L_sl65
L_sl65_b:
  v_mfma_f32_32x32x16_bf16 v[240:255], v[208:211], a[0:3], v[240:255]
  s_xor_b32 s53, s49, 20480
  buffer_load_dwordx4 v[200:203], v14, s[24:27], s53 offen offset:0 sc1
  buffer_load_dwordx4 v[204:207], v14, s[24:27], s53 offen offset:2048 sc1
  v_mfma_f32_32x32x16_bf16 v[144:159], v[208:211], a[4:7], 0
  v_mfma_f32_32x32x16_bf16 v[240:255], v[212:215], a[8:11], v[240:255]
  s_waitcnt vmcnt(12)
  v_lshl_add_u64 v[216:217], v[216:217], 0, v[28:29]
  v_lshl_add_u64 v[220:221], v[220:221], 0, v[28:29]
  v_or3_b32 v15, v216, v217, v220
  v_bitop3_b32 v15, v15, v221, s81 bitop3:0xa8
  v_cmp_ne_u32 vcc, 0, v15
  v_mfma_f32_32x32x16_bf16 v[144:159], v[212:215], a[12:15], v[144:159]
  s_cbranch_vccnz L_sl66
L_sl66_b:
  s_waitcnt lgkmcnt(8)
  v_mfma_f32_32x32x16_bf16 v[128:143], v[216:219], a[192:195], v[128:143]
  s_xor_b32 s53, s49, 24576
  buffer_load_dwordx4 v[208:211], v14, s[24:27], s53 offen offset:0 sc1
  buffer_load_dwordx4 v[212:215], v14, s[24:27], s53 offen offset:2048 sc1
  v_mfma_f32_32x32x16_bf16 v[160:175], v[216:219], a[196:199], v[160:175]
  v_mfma_f32_32x32x16_bf16 v[128:143], v[220:223], a[200:203], v[128:143]
  s_waitcnt vmcnt(12)
  v_lshl_add_u64 v[224:225], v[224:225], 0, v[28:29]
  v_lshl_add_u64 v[228:229], v[228:229], 0, v[28:29]
  v_or3_b32 v15, v224, v225, v228
  v_bitop3_b32 v15, v15, v229, s81 bitop3:0xa8
  v_cmp_ne_u32 vcc, 0, v15
  v_mfma_f32_32x32x16_bf16 v[160:175], v[220:223], a[204:207], v[160:175]
  s_cbranch_vccnz L_sl67
L_sl67_b:
  v_mfma_f32_32x32x16_bf16 v[240:255], v[224:227], a[16:19], v[240:255]
  s_xor_b32 s53, s49, 28672
  buffer_load_dwordx4 v[216:219], v14, s[24:27], s53 offen offset:0 sc1
  buffer_load_dwordx4 v[220:223], v14, s[24:27], s53 offen offset:2048 sc1
  v_mfma_f32_32x32x16_bf16 v[144:159], v[224:227], a[20:23], v[144:159]
  v_mfma_f32_32x32x16_bf16 v[240:255], v[228:231], a[24:27], v[240:255]
  s_waitcnt vmcnt(12)
  v_lshl_add_u64 v[232:233], v[232:233], 0, v[28:29]
  v_lshl_add_u64 v[236:237], v[236:237], 0, v[28:29]
  v_or3_b32 v15, v232, v233, v236
  v_bitop3_b32 v15, v15, v237, s81 bitop3:0xa8
  v_cmp_ne_u32 vcc, 0, v15
  v_mfma_f32_32x32x16_bf16 v[144:159], v[228:231], a[28:31], v[144:159]
  s_cbranch_vccnz L_sl68
L_sl68_b:
  s_waitcnt lgkmcnt(0)
  v_mfma_f32_32x32x16_bf16 v[160:175], v[232:235], a[212:215], v[160:175]
  s_xor_b32 s53, s49, 32768
  buffer_load_dwordx4 v[224:227], v14, s[24:27], s53 offen offset:0 sc1
  buffer_load_dwordx4 v[228:231], v14, s[24:27], s53 offen offset:2048 sc1
  v_mfma_f32_32x32x16_bf16 v[128:143], v[232:235], a[208:211], v[128:143]
  v_mfma_f32_32x32x16_bf16 v[160:175], v[236:239], a[220:223], v[160:175]
  s_waitcnt vmcnt(12)
  v_lshl_add_u64 v[176:177], v[176:177], 0, v[28:29]
  v_lshl_add_u64 v[180:181], v[180:181], 0, v[28:29]
  v_or3_b32 v15, v176, v177, v180
  v_bitop3_b32 v15, v15, v181, s81 bitop3:0xa8
  v_cmp_ne_u32 vcc, 0, v15
  v_mfma_f32_32x32x16_bf16 v[128:143], v[236:239], a[216:219], v[128:143]
  s_cbranch_vccnz L_sl69
L_sl69_b:
  v_mfma_f32_32x32x16_bf16 v[240:255], v[176:179], a[32:35], v[240:255]
  s_xor_b32 s53, s49, 36864
  buffer_load_dwordx4 v[232:235], v14, s[24:27], s53 offen offset:0 sc1
  buffer_load_dwordx4 v[236:239], v14, s[24:27], s53 offen offset:2048 sc1
  v_mfma_f32_32x32x16_bf16 v[144:159], v[176:179], a[36:39], v[144:159]
  ds_write_b128 v10, v[160:163] offset:0
  v_mfma_f32_32x32x16_bf16 v[240:255], v[180:183], a[40:43], v[240:255]
  s_waitcnt vmcnt(12)
  v_lshl_add_u64 v[184:185], v[184:185], 0, v[28:29]
  v_lshl_add_u64 v[188:189], v[188:189], 0, v[28:29]
  v_or3_b32 v15, v184, v185, v188
  v_bitop3_b32 v15, v15, v189, s81 bitop3:0xa8
  v_cmp_ne_u32 vcc, 0, v15
  v_mfma_f32_32x32x16_bf16 v[144:159], v[180:183], a[44:47], v[144:159]
  ds_write_b128 v10, v[164:167] offset:1024
  s_cbranch_vccnz L_sl70
L_sl70_b:
  v_mfma_f32_32x32x16_bf16 v[240:255], v[184:187], a[48:51], v[240:255]
  s_xor_b32 s53, s49, 40960
  buffer_load_dwordx4 v[176:179], v14, s[24:27], s53 offen offset:0 sc1
  buffer_load_dwordx4 v[180:183], v14, s[24:27], s53 offen offset:2048 sc1
  ds_write_b128 v10, v[168:171] offset:2048
  v_mfma_f32_32x32x16_bf16 v[144:159], v[184:187], a[52:55], v[144:159]
  ds_write_b128 v10, v[172:175] offset:3072
  v_mfma_f32_32x32x16_bf16 v[240:255], v[188:191], a[56:59], v[240:255]
  s_waitcnt vmcnt(12)
  v_lshl_add_u64 v[192:193], v[192:193], 0, v[28:29]
  v_lshl_add_u64 v[196:197], v[196:197], 0, v[28:29]
  v_or3_b32 v15, v192, v193, v196
  v_bitop3_b32 v15, v15, v197, s81 bitop3:0xa8
  v_cmp_ne_u32 vcc, 0, v15
  v_mfma_f32_32x32x16_bf16 v[144:159], v[188:191], a[60:63], v[144:159]
  s_cbranch_vccnz L_sl71
L_sl71_b:
  v_mfma_f32_32x32x16_bf16 v[240:255], v[192:195], a[64:67], v[240:255]
  s_xor_b32 s53, s49, 45056
  buffer_load_dwordx4 v[184:187], v14, s[24:27], s53 offen offset:0 sc1
  buffer_load_dwordx4 v[188:191], v14, s[24:27], s53 offen offset:2048 sc1
  s_waitcnt lgkmcnt(0)
  s_barrier
  ds_read_b128 v[160:163], v11 offset:0
  ds_read_b128 v[164:167], v11 offset:1024
  v_mfma_f32_32x32x16_bf16 v[144:159], v[192:195], a[68:71], v[144:159]
  ds_read_b128 v[168:171], v11 offset:2048
  ds_read_b128 v[172:175], v11 offset:3072
  v_mfma_f32_32x32x16_bf16 v[240:255], v[196:199], a[72:75], v[240:255]
  s_waitcnt vmcnt(12)
  v_lshl_add_u64 v[200:201], v[200:201], 0, v[28:29]
  v_lshl_add_u64 v[204:205], v[204:205], 0, v[28:29]
  v_or3_b32 v15, v200, v201, v204
  v_bitop3_b32 v15, v15, v205, s81 bitop3:0xa8
  v_cmp_ne_u32 vcc, 0, v15
  v_mfma_f32_32x32x16_bf16 v[144:159], v[196:199], a[76:79], v[144:159]
  s_cbranch_vccnz L_sl72
L_sl72_b:
  v_mfma_f32_32x32x16_bf16 v[240:255], v[200:203], a[80:83], v[240:255]
  s_xor_b32 s53, s49, 49152
  buffer_load_dwordx4 v[192:195], v14, s[24:27], s53 offen offset:0 sc1
  buffer_load_dwordx4 v[196:199], v14, s[24:27], s53 offen offset:2048 sc1
  s_waitcnt lgkmcnt(3)
  v_add_f32 v128, v128, v160
  v_add_f32 v129, v129, v161
  v_add_f32 v130, v130, v162
  v_add_f32 v131, v131, v163
  v_mfma_f32_32x32x16_bf16 v[144:159], v[200:203], a[84:87], v[144:159]
  v_cvt_pk_bf16_f32 v128, v128, v129
  v_cvt_pk_bf16_f32 v129, v130, v131
  s_waitcnt lgkmcnt(2)
  v_add_f32 v132, v132, v164
  v_add_f32 v133, v133, v165
  v_add_f32 v134, v134, v166
  v_add_f32 v135, v135, v167
  v_mfma_f32_32x32x16_bf16 v[240:255], v[204:207], a[88:91], v[240:255]
  s_waitcnt vmcnt(12)
  v_lshl_add_u64 v[208:209], v[208:209], 0, v[28:29]
  v_lshl_add_u64 v[212:213], v[212:213], 0, v[28:29]
  v_or3_b32 v15, v208, v209, v212
  v_bitop3_b32 v15, v15, v213, s81 bitop3:0xa8
  v_cmp_ne_u32 vcc, 0, v15
  v_mfma_f32_32x32x16_bf16 v[144:159], v[204:207], a[92:95], v[144:159]
  v_lshl_add_u64 v[128:129], v[128:129], 0, v[60:61]
  v_cvt_pk_bf16_f32 v130, v132, v133
  v_cvt_pk_bf16_f32 v131, v134, v135
  s_cbranch_vccnz L_sl73
L_sl73_b:
  v_mfma_f32_32x32x16_bf16 v[240:255], v[208:211], a[96:99], v[240:255]
  s_xor_b32 s53, s49, 53248
  buffer_load_dwordx4 v[200:203], v14, s[24:27], s53 offen offset:0 sc1
  buffer_load_dwordx4 v[204:207], v14, s[24:27], s53 offen offset:2048 sc1
  s_waitcnt lgkmcnt(1)
  v_add_f32 v136, v136, v168
  v_add_f32 v137, v137, v169
  v_add_f32 v138, v138, v170
  v_add_f32 v139, v139, v171
  s_cmp_eq_u32 s47, 0
  s_cbranch_scc0 L_ss74
  buffer_store_dwordx4 v[128:131], v13, s[24:27], 0 offen offset:0
L_ss74_e:
  v_mfma_f32_32x32x16_bf16 v[144:159], v[208:211], a[100:103], v[144:159]
  v_cvt_pk_bf16_f32 v132, v136, v137
  v_cvt_pk_bf16_f32 v133, v138, v139
  s_waitcnt lgkmcnt(0)
  v_add_f32 v140, v140, v172
  v_add_f32 v141, v141, v173
  v_add_f32 v142, v142, v174
  v_add_f32 v143, v143, v175
  v_mfma_f32_32x32x16_bf16 v[240:255], v[212:215], a[104:107], v[240:255]
  s_waitcnt vmcnt(13)
  v_lshl_add_u64 v[216:217], v[216:217], 0, v[28:29]
  v_lshl_add_u64 v[220:221], v[220:221], 0, v[28:29]
  v_or3_b32 v15, v216, v217, v220
  v_bitop3_b32 v15, v15, v221, s81 bitop3:0xa8
  v_cmp_ne_u32 vcc, 0, v15
  v_mfma_f32_32x32x16_bf16 v[144:159], v[212:215], a[108:111], v[144:159]
  v_lshl_add_u64 v[132:133], v[132:133], 0, v[60:61]
  v_cvt_pk_bf16_f32 v134, v140, v141
  v_cvt_pk_bf16_f32 v135, v142, v143
  s_cbranch_vccnz L_sl75
L_sl75_b:
  v_mfma_f32_32x32x16_bf16 v[240:255], v[216:219], a[112:115], v[240:255]
  s_cmp_eq_u32 s47, 0
  s_cbranch_scc0 L_ss76
  buffer_store_dwordx4 v[132:135], v13, s[24:27], 0 offen offset:1024
L_ss76_e:
  v_mfma_f32_32x32x16_bf16 v[144:159], v[216:219], a[116:119], v[144:159]
  v_mfma_f32_32x32x16_bf16 v[240:255], v[220:223], a[120:123], v[240:255]
  s_waitcnt vmcnt(12)
  v_lshl_add_u64 v[224:225], v[224:225], 0, v[28:29]
  v_lshl_add_u64 v[228:229], v[228:229], 0, v[28:29]
  v_or3_b32 v15, v224, v225, v228
  v_bitop3_b32 v15, v15, v229, s81 bitop3:0xa8
  v_cmp_ne_u32 vcc, 0, v15
  v_mfma_f32_32x32x16_bf16 v[144:159], v[220:223], a[124:127], v[144:159]
  s_cbranch_vccnz L_sl77
L_sl77_b:
  v_mfma_f32_32x32x16_bf16 v[240:255], v[224:227], a[128:131], v[240:255]
  v_mfma_f32_32x32x16_bf16 v[144:159], v[224:227], a[132:135], v[144:159]
  v_mfma_f32_32x32x16_bf16 v[240:255], v[228:231], a[136:139], v[240:255]
  s_waitcnt vmcnt(10)
  v_lshl_add_u64 v[232:233], v[232:233], 0, v[28:29]
  v_lshl_add_u64 v[236:237], v[236:237], 0, v[28:29]
  v_or3_b32 v15, v232, v233, v236
  v_bitop3_b32 v15, v15, v237, s81 bitop3:0xa8
  v_cmp_ne_u32 vcc, 0, v15
  v_mfma_f32_32x32x16_bf16 v[144:159], v[228:231], a[140:143], v[144:159]
  s_cbranch_vccnz L_sl78
L_sl78_b:
  v_mfma_f32_32x32x16_bf16 v[240:255], v[232:235], a[144:147], v[240:255]
  v_mfma_f32_32x32x16_bf16 v[144:159], v[232:235], a[148:151], v[144:159]
  v_mfma_f32_32x32x16_bf16 v[240:255], v[236:239], a[152:155], v[240:255]
  s_waitcnt vmcnt(8)
  v_lshl_add_u64 v[176:177], v[176:177], 0, v[28:29]
  v_lshl_add_u64 v[180:181], v[180:181], 0, v[28:29]
  v_or3_b32 v15, v176, v177, v180
  v_bitop3_b32 v15, v15, v181, s81 bitop3:0xa8
  v_cmp_ne_u32 vcc, 0, v15
  v_mfma_f32_32x32x16_bf16 v[144:159], v[236:239], a[156:159], v[144:159]
  s_cbranch_vccnz L_sl79
L_sl79_b:
  v_mfma_f32_32x32x16_bf16 v[240:255], v[176:179], a[160:163], v[240:255]
  v_mfma_f32_32x32x16_bf16 v[144:159], v[176:179], a[164:167], v[144:159]
  v_mfma_f32_32x32x16_bf16 v[240:255], v[180:183], a[168:171], v[240:255]
  s_waitcnt vmcnt(6)
  v_lshl_add_u64 v[184:185], v[184:185], 0, v[28:29]
  v_lshl_add_u64 v[188:189], v[188:189], 0, v[28:29]
  v_or3_b32 v15, v184, v185, v188
  v_bitop3_b32 v15, v15, v189, s81 bitop3:0xa8
  v_cmp_ne_u32 vcc, 0, v15
  v_mfma_f32_32x32x16_bf16 v[144:159], v[180:183], a[172:175], v[144:159]
  s_cbranch_vccnz L_sl80
L_sl80_b:
  v_mfma_f32_32x32x16_bf16 v[240:255], v[184:187], a[176:179], v[240:255]
  v_mfma_f32_32x32x16_bf16 v[144:159], v[184:187], a[180:183], v[144:159]
  v_mfma_f32_32x32x16_bf16 v[240:255], v[188:191], a[184:187], v[240:255]
  s_waitcnt vmcnt(4)
  v_lshl_add_u64 v[192:193], v[192:193], 0, v[28:29]
  v_lshl_add_u64 v[196:197], v[196:197], 0, v[28:29]
  v_or3_b32 v15, v192, v193, v196
  v_bitop3_b32 v15, v15, v197, s81 bitop3:0xa8
  v_cmp_ne_u32 vcc, 0, v15
  v_mfma_f32_32x32x16_bf16 v[144:159], v[188:191], a[188:191], v[144:159]
  s_cbranch_vccnz L_sl81
L_sl81_b:
  v_mfma_f32_32x32x16_bf16 v[240:255], v[192:195], a[192:195], v[240:255]
  buffer_load_dwordx4 v[136:139], v12, s[24:27], 0 offen offset:0 sc1
  buffer_load_dwordx4 v[140:143], v12, s[24:27], 0 offen offset:1024 sc1
  v_mfma_f32_32x32x16_bf16 v[144:159], v[192:195], a[196:199], v[144:159]
  v_mfma_f32_32x32x16_bf16 v[240:255], v[196:199], a[200:203], v[240:255]
  s_waitcnt vmcnt(4)
  v_lshl_add_u64 v[200:201], v[200:201], 0, v[28:29]
  v_lshl_add_u64 v[204:205], v[204:205], 0, v[28:29]
  v_or3_b32 v15, v200, v201, v204
  v_bitop3_b32 v15, v15, v205, s81 bitop3:0xa8
  v_cmp_ne_u32 vcc, 0, v15
  v_mfma_f32_32x32x16_bf16 v[144:159], v[196:199], a[204:207], v[144:159]
  s_cbranch_vccnz L_sl82
L_sl82_b:
  v_mfma_f32_32x32x16_bf16 v[144:159], v[200:203], a[212:215], v[144:159]
  v_mfma_f32_32x32x16_bf16 v[144:159], v[204:207], a[220:223], v[144:159]
  v_mfma_f32_32x32x16_bf16 v[240:255], v[200:203], a[208:211], v[240:255]
  v_mfma_f32_32x32x16_bf16 v[240:255], v[204:207], a[216:219], v[240:255]
  s_lshr_b32 s53, s54, 16
  s_nop 8
  ds_write_b128 v11, v[144:147] offset:0
  ds_write_b128 v11, v[148:151] offset:1024
  ds_write_b128 v11, v[152:155] offset:2048
  ds_write_b128 v11, v[156:159] offset:3072
  v_pk_mul_f32 v[240:241], v[240:241], s[54:55]
  v_pk_mul_f32 v[242:243], v[242:243], s[54:55]
  v_pk_mul_f32 v[244:245], v[244:245], s[54:55]
  v_pk_mul_f32 v[246:247], v[246:247], s[54:55]
  v_pk_mul_f32 v[248:249], v[248:249], s[54:55]
  v_pk_mul_f32 v[250:251], v[250:251], s[54:55]
  v_pk_mul_f32 v[252:253], v[252:253], s[54:55]
  v_pk_mul_f32 v[254:255], v[254:255], s[54:55]
  s_waitcnt lgkmcnt(0)
  s_barrier
  ds_read_b128 v[176:179], v10 offset:0
  ds_read_b128 v[180:183], v10 offset:1024
  ds_read_b128 v[184:187], v10 offset:2048
  ds_read_b128 v[188:191], v10 offset:3072
  s_waitcnt vmcnt(0)
  v_lshl_add_u64 v[136:137], v[136:137], 0, v[62:63]
  v_lshl_add_u64 v[140:141], v[140:141], 0, v[62:63]
  v_or3_b32 v16, v136, v137, v140
  v_bitop3_b32 v16, v16, v141, s81 bitop3:0xa8
  v_cmp_ne_u32 vcc, 0, v16
  s_cbranch_vccnz L_sl83
L_sl83_b:
  v_dot2c_f32_bf16 v240, s53, v136
  v_dot2c_f32_bf16 v241, s54, v136
  v_dot2c_f32_bf16 v242, s53, v137
  v_dot2c_f32_bf16 v243, s54, v137
  v_dot2c_f32_bf16 v244, s53, v138
  v_dot2c_f32_bf16 v245, s54, v138
  v_dot2c_f32_bf16 v246, s53, v139
  v_dot2c_f32_bf16 v247, s54, v139
  v_dot2c_f32_bf16 v248, s53, v140
  v_dot2c_f32_bf16 v249, s54, v140
  v_dot2c_f32_bf16 v250, s53, v141
  v_dot2c_f32_bf16 v251, s54, v141
  v_dot2c_f32_bf16 v252, s53, v142
  v_dot2c_f32_bf16 v253, s54, v142
  v_dot2c_f32_bf16 v254, s53, v143
  v_dot2c_f32_bf16 v255, s54, v143
  s_waitcnt lgkmcnt(3)
  v_pk_fma_f32 v[240:241], v[176:177], s[54:55], v[240:241]
  v_pk_fma_f32 v[242:243], v[178:179], s[54:55], v[242:243]
  s_waitcnt lgkmcnt(2)
  v_pk_fma_f32 v[244:245], v[180:181], s[54:55], v[244:245]
  v_pk_fma_f32 v[246:247], v[182:183], s[54:55], v[246:247]
  s_waitcnt lgkmcnt(1)
  v_pk_fma_f32 v[248:249], v[184:185], s[54:55], v[248:249]
  v_pk_fma_f32 v[250:251], v[186:187], s[54:55], v[250:251]
  s_waitcnt lgkmcnt(0)
  v_pk_fma_f32 v[252:253], v[188:189], s[54:55], v[252:253]
  v_pk_fma_f32 v[254:255], v[190:191], s[54:55], v[254:255]
  v_cvt_pk_bf16_f32 v38, v240, v241
  v_cvt_pk_bf16_f32 v39, v242, v243
  v_cvt_pk_bf16_f32 v40, v244, v245
  v_cvt_pk_bf16_f32 v41, v246, v247
  s_nop 0
  v_permlane32_swap_b32 v38, v40
  v_permlane32_swap_b32 v39, v41
  buffer_store_dwordx4 v[38:41], v34, s[28:31], 0 offen offset:0
  v_cvt_pk_bf16_f32 v42, v248, v249
  v_cvt_pk_bf16_f32 v43, v250, v251
  v_cvt_pk_bf16_f32 v44, v252, v253
  v_cvt_pk_bf16_f32 v45, v254, v255
  s_nop 0
  v_permlane32_swap_b32 v42, v44
  v_permlane32_swap_b32 v43, v45
  buffer_store_dwordx4 v[42:45], v34, s[28:31], 0 offen offset:32
  buffer_store_dword v37, v36, s[24:27], 0 offen sc1
  s_endpgm
L_loopB:
  ds_read_b64_tr_b16 v[86:87], v199 offset:0
  ds_read_b64_tr_b16 v[88:89], v199 offset:512
  ds_read_b64_tr_b16 v[90:91], v199 offset:1024
  ds_read_b64_tr_b16 v[92:93], v199 offset:1536
  ds_read_b64_tr_b16 v[94:95], v199 offset:2048
  ds_read_b64_tr_b16 v[96:97], v199 offset:2560
  ds_read_b128 v[46:49], v197 offset:16384
  ds_read_b128 v[50:53], v45 offset:16384
  ds_read_b128 v[54:57], v45 offset:24576
  ds_read_b128 v[58:61], v45 offset:3072
  ds_read_b128 v[62:65], v45 offset:11264
  s_waitcnt lgkmcnt(4)
  v_mfma_f32_16x16x32_bf16 v[170:173], v[46:49], v[46:49], 0
  ds_read_b64_tr_b16 v[98:99], v200 offset:0
  s_xor_b32 s54, s51, 256
  v_mfma_f32_16x16x32_bf16 v[110:113], v[86:89], v[46:49], 0
  ds_read_b64_tr_b16 v[100:101], v200 offset:512
  s_mul_i32 s55, s54, 1536
  v_mfma_f32_16x16x32_bf16 v[130:133], v[90:93], v[46:49], 0
  ds_read_b64_tr_b16 v[102:103], v200 offset:1024
  s_add_u32 m0, s44, 114688
  v_mfma_f32_16x16x32_bf16 v[150:153], v[46:49], v[94:97], 0
  ds_read_b64_tr_b16 v[104:105], v200 offset:1536
  s_waitcnt lgkmcnt(4)
  v_mfma_f32_16x16x32_bf16 v[174:177], v[50:53], v[50:53], 0
  ds_read_b64_tr_b16 v[106:107], v200 offset:2048
  buffer_load_dwordx4 v33, s[4:7], s54 offen offset:0 lds
  v_mfma_f32_16x16x32_bf16 v[114:117], v[86:89], v[50:53], 0
  ds_read_b64_tr_b16 v[108:109], v200 offset:2560
  v_mfma_f32_16x16x32_bf16 v[134:137], v[90:93], v[50:53], 0
  ds_read_b128 v[66:69], v198 offset:16384
  v_mfma_f32_16x16x32_bf16 v[154:157], v[50:53], v[94:97], 0
  ds_read_b128 v[70:73], v194 offset:16384
  buffer_load_dwordx4 v37, s[8:11], s55 offen offset:1024 lds
  v_mfma_f32_16x16x32_bf16 v[178:181], v[54:57], v[54:57], 0
  ds_read_b128 v[74:77], v194 offset:24576
  v_mfma_f32_16x16x32_bf16 v[118:121], v[86:89], v[54:57], 0
  ds_read_b128 v[78:81], v194 offset:3072
  v_mfma_f32_16x16x32_bf16 v[138:141], v[90:93], v[54:57], 0
  ds_read_b128 v[82:85], v194 offset:11264
  buffer_load_dwordx4 v37, s[8:11], s55 offen offset:2048 lds
  v_mfma_f32_16x16x32_bf16 v[158:161], v[54:57], v[94:97], 0
  v_mfma_f32_16x16x32_bf16 v[182:185], v[58:61], v[58:61], 0
  v_mfma_f32_16x16x32_bf16 v[122:125], v[86:89], v[58:61], 0
  buffer_load_dwordx4 v37, s[8:11], s55 offen offset:3072 lds
  s_add_u32 m0, s44, 98304
  v_mfma_f32_16x16x32_bf16 v[142:145], v[90:93], v[58:61], 0
  v_mfma_f32_16x16x32_bf16 v[162:165], v[58:61], v[94:97], 0
  v_mfma_f32_16x16x32_bf16 v[186:189], v[62:65], v[62:65], 0
  buffer_load_dwordx4 v34, s[4:7], s54 offen offset:3072 lds
  v_mfma_f32_16x16x32_bf16 v[126:129], v[86:89], v[62:65], 0
  v_mfma_f32_16x16x32_bf16 v[146:149], v[90:93], v[62:65], 0
  v_mfma_f32_16x16x32_bf16 v[166:169], v[62:65], v[94:97], 0
  buffer_load_dwordx4 v36, s[8:11], s55 offen offset:0 lds
  s_waitcnt lgkmcnt(0)
  s_waitcnt vmcnt(9)
  s_barrier
  v_mfma_f32_16x16x32_bf16 v[110:113], v[98:101], v[66:69], v[110:113]
  ds_read_b64_tr_b16 v[86:87], v199 offset:32768
  v_mfma_f32_16x16x32_bf16 v[130:133], v[102:105], v[66:69], v[130:133]
  ds_read_b64_tr_b16 v[88:89], v199 offset:33280
  v_mfma_f32_16x16x32_bf16 v[150:153], v[66:69], v[106:109], v[150:153]
  ds_read_b64_tr_b16 v[90:91], v199 offset:33792
  buffer_load_dwordx4 v36, s[8:11], s55 offen offset:1024 lds
  v_mfma_f32_16x16x32_bf16 v[114:117], v[98:101], v[70:73], v[114:117]
  ds_read_b64_tr_b16 v[92:93], v199 offset:34304
  v_mfma_f32_16x16x32_bf16 v[134:137], v[102:105], v[70:73], v[134:137]
  ds_read_b64_tr_b16 v[94:95], v199 offset:34816
  v_mfma_f32_16x16x32_bf16 v[154:157], v[70:73], v[106:109], v[154:157]
  ds_read_b64_tr_b16 v[96:97], v199 offset:35328
  buffer_load_dwordx4 v36, s[8:11], s55 offen offset:2048 lds
  v_mfma_f32_16x16x32_bf16 v[118:121], v[98:101], v[74:77], v[118:121]
  ds_read_b128 v[46:49], v197 offset:17408
  s_add_u32 m0, s36, 28672
  v_mfma_f32_16x16x32_bf16 v[138:141], v[102:105], v[74:77], v[138:141]
  ds_read_b128 v[50:53], v45 offset:49152
  v_mfma_f32_16x16x32_bf16 v[158:161], v[74:77], v[106:109], v[158:161]
  ds_read_b128 v[54:57], v45 offset:57344
  buffer_load_dwordx4 v35, s[4:7], s53 offen offset:0 lds
  v_mfma_f32_16x16x32_bf16 v[122:125], v[98:101], v[78:81], v[122:125]
  ds_read_b128 v[58:61], v45 offset:35840
  s_xor_b32 s54, s51, 384
  v_mfma_f32_16x16x32_bf16 v[142:145], v[102:105], v[78:81], v[142:145]
  ds_read_b128 v[62:65], v45 offset:44032
  s_mul_i32 s55, s54, 1536
  v_mfma_f32_16x16x32_bf16 v[162:165], v[78:81], v[106:109], v[162:165]
  s_add_u32 m0, s44, 147456
  s_nop 0
  buffer_load_dwordx4 v33, s[4:7], s54 offen offset:0 lds
  v_mfma_f32_16x16x32_bf16 v[126:129], v[98:101], v[82:85], v[126:129]
  v_mfma_f32_16x16x32_bf16 v[146:149], v[102:105], v[82:85], v[146:149]
  v_mfma_f32_16x16x32_bf16 v[166:169], v[82:85], v[106:109], v[166:169]
  buffer_load_dwordx4 v37, s[8:11], s55 offen offset:1024 lds
  s_waitcnt lgkmcnt(3)
  v_mfma_f32_16x16x32_bf16 v[170:173], v[46:49], v[46:49], v[170:173]
  ds_read_b64_tr_b16 v[98:99], v200 offset:32768
  v_mfma_f32_16x16x32_bf16 v[110:113], v[86:89], v[46:49], v[110:113]
  ds_read_b64_tr_b16 v[100:101], v200 offset:33280
  v_mfma_f32_16x16x32_bf16 v[130:133], v[90:93], v[46:49], v[130:133]
  ds_read_b64_tr_b16 v[102:103], v200 offset:33792
  buffer_load_dwordx4 v37, s[8:11], s55 offen offset:2048 lds
  v_mfma_f32_16x16x32_bf16 v[150:153], v[46:49], v[94:97], v[150:153]
  ds_read_b64_tr_b16 v[104:105], v200 offset:34304
  v_mfma_f32_16x16x32_bf16 v[174:177], v[50:53], v[50:53], v[174:177]
  ds_read_b64_tr_b16 v[106:107], v200 offset:34816
  v_mfma_f32_16x16x32_bf16 v[114:117], v[86:89], v[50:53], v[114:117]
  ds_read_b64_tr_b16 v[108:109], v200 offset:35328
  buffer_load_dwordx4 v37, s[8:11], s55 offen offset:3072 lds
  v_mfma_f32_16x16x32_bf16 v[134:137], v[90:93], v[50:53], v[134:137]
  ds_read_b128 v[66:69], v198 offset:17408
  s_add_u32 m0, s44, 131072
  v_mfma_f32_16x16x32_bf16 v[154:157], v[50:53], v[94:97], v[154:157]
  ds_read_b128 v[70:73], v194 offset:49152
  s_waitcnt lgkmcnt(8)
  v_mfma_f32_16x16x32_bf16 v[178:181], v[54:57], v[54:57], v[178:181]
  ds_read_b128 v[74:77], v194 offset:57344
  buffer_load_dwordx4 v34, s[4:7], s54 offen offset:3072 lds
  v_mfma_f32_16x16x32_bf16 v[118:121], v[86:89], v[54:57], v[118:121]
  ds_read_b128 v[78:81], v194 offset:35840
  v_mfma_f32_16x16x32_bf16 v[138:141], v[90:93], v[54:57], v[138:141]
  ds_read_b128 v[82:85], v194 offset:44032
  v_mfma_f32_16x16x32_bf16 v[158:161], v[54:57], v[94:97], v[158:161]
  buffer_load_dwordx4 v36, s[8:11], s55 offen offset:0 lds
  v_mfma_f32_16x16x32_bf16 v[182:185], v[58:61], v[58:61], v[182:185]
  v_mfma_f32_16x16x32_bf16 v[122:125], v[86:89], v[58:61], v[122:125]
  v_mfma_f32_16x16x32_bf16 v[142:145], v[90:93], v[58:61], v[142:145]
  buffer_load_dwordx4 v36, s[8:11], s55 offen offset:1024 lds
  v_mfma_f32_16x16x32_bf16 v[162:165], v[58:61], v[94:97], v[162:165]
  v_mfma_f32_16x16x32_bf16 v[186:189], v[62:65], v[62:65], v[186:189]
  v_mfma_f32_16x16x32_bf16 v[126:129], v[86:89], v[62:65], v[126:129]
  buffer_load_dwordx4 v36, s[8:11], s55 offen offset:2048 lds
  v_mfma_f32_16x16x32_bf16 v[146:149], v[90:93], v[62:65], v[146:149]
  v_mfma_f32_16x16x32_bf16 v[166:169], v[62:65], v[94:97], v[166:169]
  s_waitcnt lgkmcnt(0)
  s_waitcnt vmcnt(9)
  s_barrier
  v_mfma_f32_16x16x32_bf16 v[110:113], v[98:101], v[66:69], v[110:113]
  ds_read_b64_tr_b16 v[86:87], v201 offset:0
  s_xor_b32 s54, s51, 512
  v_mfma_f32_16x16x32_bf16 v[130:133], v[102:105], v[66:69], v[130:133]
  ds_read_b64_tr_b16 v[88:89], v201 offset:512
  s_mul_i32 s55, s54, 1536
  v_mfma_f32_16x16x32_bf16 v[150:153], v[66:69], v[106:109], v[150:153]
  ds_read_b64_tr_b16 v[90:91], v201 offset:1024
  s_add_u32 m0, s44, 49152
  v_mfma_f32_16x16x32_bf16 v[114:117], v[98:101], v[70:73], v[114:117]
  ds_read_b64_tr_b16 v[92:93], v201 offset:1536
  buffer_load_dwordx4 v33, s[4:7], s54 offen offset:0 lds
  v_mfma_f32_16x16x32_bf16 v[134:137], v[102:105], v[70:73], v[134:137]
  ds_read_b64_tr_b16 v[94:95], v201 offset:2048
  v_mfma_f32_16x16x32_bf16 v[154:157], v[70:73], v[106:109], v[154:157]
  ds_read_b64_tr_b16 v[96:97], v201 offset:2560
  v_mfma_f32_16x16x32_bf16 v[118:121], v[98:101], v[74:77], v[118:121]
  ds_read_b128 v[46:49], v197 offset:18432
  buffer_load_dwordx4 v37, s[8:11], s55 offen offset:1024 lds
  v_mfma_f32_16x16x32_bf16 v[138:141], v[102:105], v[74:77], v[138:141]
  ds_read_b128 v[50:53], v195 offset:16384
  v_mfma_f32_16x16x32_bf16 v[158:161], v[74:77], v[106:109], v[158:161]
  ds_read_b128 v[54:57], v195 offset:24576
  v_mfma_f32_16x16x32_bf16 v[122:125], v[98:101], v[78:81], v[122:125]
  ds_read_b128 v[58:61], v195 offset:3072
  buffer_load_dwordx4 v37, s[8:11], s55 offen offset:2048 lds
  v_mfma_f32_16x16x32_bf16 v[142:145], v[102:105], v[78:81], v[142:145]
  ds_read_b128 v[62:65], v195 offset:11264
  v_mfma_f32_16x16x32_bf16 v[162:165], v[78:81], v[106:109], v[162:165]
  v_mfma_f32_16x16x32_bf16 v[126:129], v[98:101], v[82:85], v[126:129]
  buffer_load_dwordx4 v37, s[8:11], s55 offen offset:3072 lds
  s_add_u32 m0, s44, 32768
  v_mfma_f32_16x16x32_bf16 v[146:149], v[102:105], v[82:85], v[146:149]
  v_mfma_f32_16x16x32_bf16 v[166:169], v[82:85], v[106:109], v[166:169]
  s_waitcnt lgkmcnt(3)
  v_mfma_f32_16x16x32_bf16 v[170:173], v[46:49], v[46:49], v[170:173]
  ds_read_b64_tr_b16 v[98:99], v202 offset:0
  buffer_load_dwordx4 v34, s[4:7], s54 offen offset:3072 lds
  v_mfma_f32_16x16x32_bf16 v[110:113], v[86:89], v[46:49], v[110:113]
  ds_read_b64_tr_b16 v[100:101], v202 offset:512
  v_mfma_f32_16x16x32_bf16 v[130:133], v[90:93], v[46:49], v[130:133]
  ds_read_b64_tr_b16 v[102:103], v202 offset:1024
  v_mfma_f32_16x16x32_bf16 v[150:153], v[46:49], v[94:97], v[150:153]
  ds_read_b64_tr_b16 v[104:105], v202 offset:1536
  buffer_load_dwordx4 v36, s[8:11], s55 offen offset:0 lds
  v_mfma_f32_16x16x32_bf16 v[174:177], v[50:53], v[50:53], v[174:177]
  ds_read_b64_tr_b16 v[106:107], v202 offset:2048
  v_mfma_f32_16x16x32_bf16 v[114:117], v[86:89], v[50:53], v[114:117]
  ds_read_b64_tr_b16 v[108:109], v202 offset:2560
  v_mfma_f32_16x16x32_bf16 v[134:137], v[90:93], v[50:53], v[134:137]
  ds_read_b128 v[66:69], v198 offset:18432
  buffer_load_dwordx4 v36, s[8:11], s55 offen offset:1024 lds
  v_mfma_f32_16x16x32_bf16 v[154:157], v[50:53], v[94:97], v[154:157]
  ds_read_b128 v[70:73], v196 offset:16384
  s_waitcnt lgkmcnt(8)
  v_mfma_f32_16x16x32_bf16 v[178:181], v[54:57], v[54:57], v[178:181]
  ds_read_b128 v[74:77], v196 offset:24576
  v_mfma_f32_16x16x32_bf16 v[118:121], v[86:89], v[54:57], v[118:121]
  ds_read_b128 v[78:81], v196 offset:3072
  buffer_load_dwordx4 v36, s[8:11], s55 offen offset:2048 lds
  v_mfma_f32_16x16x32_bf16 v[138:141], v[90:93], v[54:57], v[138:141]
  ds_read_b128 v[82:85], v196 offset:11264
  v_mfma_f32_16x16x32_bf16 v[158:161], v[54:57], v[94:97], v[158:161]
  v_mfma_f32_16x16x32_bf16 v[182:185], v[58:61], v[58:61], v[182:185]
  v_mfma_f32_16x16x32_bf16 v[122:125], v[86:89], v[58:61], v[122:125]
  v_mfma_f32_16x16x32_bf16 v[142:145], v[90:93], v[58:61], v[142:145]
  v_mfma_f32_16x16x32_bf16 v[162:165], v[58:61], v[94:97], v[162:165]
  v_mfma_f32_16x16x32_bf16 v[186:189], v[62:65], v[62:65], v[186:189]
  v_mfma_f32_16x16x32_bf16 v[126:129], v[86:89], v[62:65], v[126:129]
  v_mfma_f32_16x16x32_bf16 v[146:149], v[90:93], v[62:65], v[146:149]
  v_mfma_f32_16x16x32_bf16 v[166:169], v[62:65], v[94:97], v[166:169]
  s_waitcnt lgkmcnt(0)
  s_waitcnt vmcnt(8)
  s_barrier
  v_mfma_f32_16x16x32_bf16 v[110:113], v[98:101], v[66:69], v[110:113]
  ds_read_b64_tr_b16 v[86:87], v201 offset:32768
  s_xor_b32 s54, s51, 640
  v_mfma_f32_16x16x32_bf16 v[130:133], v[102:105], v[66:69], v[130:133]
  ds_read_b64_tr_b16 v[88:89], v201 offset:33280
  s_mul_i32 s55, s54, 1536
  v_mfma_f32_16x16x32_bf16 v[150:153], v[66:69], v[106:109], v[150:153]
  ds_read_b64_tr_b16 v[90:91], v201 offset:33792
  s_add_u32 m0, s44, 81920
  v_mfma_f32_16x16x32_bf16 v[114:117], v[98:101], v[70:73], v[114:117]
  ds_read_b64_tr_b16 v[92:93], v201 offset:34304
  buffer_load_dwordx4 v33, s[4:7], s54 offen offset:0 lds
  v_mfma_f32_16x16x32_bf16 v[134:137], v[102:105], v[70:73], v[134:137]
  ds_read_b64_tr_b16 v[94:95], v201 offset:34816
  v_mfma_f32_16x16x32_bf16 v[154:157], v[70:73], v[106:109], v[154:157]
  ds_read_b64_tr_b16 v[96:97], v201 offset:35328
  v_mfma_f32_16x16x32_bf16 v[118:121], v[98:101], v[74:77], v[118:121]
  ds_read_b128 v[46:49], v197 offset:19456
  buffer_load_dwordx4 v37, s[8:11], s55 offen offset:1024 lds
  v_mfma_f32_16x16x32_bf16 v[138:141], v[102:105], v[74:77], v[138:141]
  ds_read_b128 v[50:53], v195 offset:49152
  v_mfma_f32_16x16x32_bf16 v[158:161], v[74:77], v[106:109], v[158:161]
  ds_read_b128 v[54:57], v195 offset:57344
  v_mfma_f32_16x16x32_bf16 v[122:125], v[98:101], v[78:81], v[122:125]
  ds_read_b128 v[58:61], v195 offset:35840
  buffer_load_dwordx4 v37, s[8:11], s55 offen offset:2048 lds
  v_mfma_f32_16x16x32_bf16 v[142:145], v[102:105], v[78:81], v[142:145]
  ds_read_b128 v[62:65], v195 offset:44032
  v_mfma_f32_16x16x32_bf16 v[162:165], v[78:81], v[106:109], v[162:165]
  v_mfma_f32_16x16x32_bf16 v[126:129], v[98:101], v[82:85], v[126:129]
  buffer_load_dwordx4 v37, s[8:11], s55 offen offset:3072 lds
  s_add_u32 m0, s44, 65536
  v_mfma_f32_16x16x32_bf16 v[146:149], v[102:105], v[82:85], v[146:149]
  v_mfma_f32_16x16x32_bf16 v[166:169], v[82:85], v[106:109], v[166:169]
  s_waitcnt lgkmcnt(3)
  v_mfma_f32_16x16x32_bf16 v[170:173], v[46:49], v[46:49], v[170:173]
  ds_read_b64_tr_b16 v[98:99], v202 offset:32768
  buffer_load_dwordx4 v34, s[4:7], s54 offen offset:3072 lds
  v_mfma_f32_16x16x32_bf16 v[110:113], v[86:89], v[46:49], v[110:113]
  ds_read_b64_tr_b16 v[100:101], v202 offset:33280
  v_mfma_f32_16x16x32_bf16 v[130:133], v[90:93], v[46:49], v[130:133]
  ds_read_b64_tr_b16 v[102:103], v202 offset:33792
  v_mfma_f32_16x16x32_bf16 v[150:153], v[46:49], v[94:97], v[150:153]
  ds_read_b64_tr_b16 v[104:105], v202 offset:34304
  buffer_load_dwordx4 v36, s[8:11], s55 offen offset:0 lds
  v_mfma_f32_16x16x32_bf16 v[174:177], v[50:53], v[50:53], v[174:177]
  ds_read_b64_tr_b16 v[106:107], v202 offset:34816
  v_mfma_f32_16x16x32_bf16 v[114:117], v[86:89], v[50:53], v[114:117]
  ds_read_b64_tr_b16 v[108:109], v202 offset:35328
  v_mfma_f32_16x16x32_bf16 v[134:137], v[90:93], v[50:53], v[134:137]
  ds_read_b128 v[66:69], v198 offset:19456
  buffer_load_dwordx4 v36, s[8:11], s55 offen offset:1024 lds
  v_mfma_f32_16x16x32_bf16 v[154:157], v[50:53], v[94:97], v[154:157]
  ds_read_b128 v[70:73], v196 offset:49152
  s_waitcnt lgkmcnt(8)
  v_mfma_f32_16x16x32_bf16 v[178:181], v[54:57], v[54:57], v[178:181]
  ds_read_b128 v[74:77], v196 offset:57344
  v_mfma_f32_16x16x32_bf16 v[118:121], v[86:89], v[54:57], v[118:121]
  ds_read_b128 v[78:81], v196 offset:35840
  buffer_load_dwordx4 v36, s[8:11], s55 offen offset:2048 lds
  v_mfma_f32_16x16x32_bf16 v[138:141], v[90:93], v[54:57], v[138:141]
  ds_read_b128 v[82:85], v196 offset:44032
  v_mfma_f32_16x16x32_bf16 v[158:161], v[54:57], v[94:97], v[158:161]
  v_mfma_f32_16x16x32_bf16 v[182:185], v[58:61], v[58:61], v[182:185]
  buffer_store_dword v14, v13, s[24:27], 0 offen offset:0 sc1
  v_mfma_f32_16x16x32_bf16 v[122:125], v[86:89], v[58:61], v[122:125]
  v_mfma_f32_16x16x32_bf16 v[142:145], v[90:93], v[58:61], v[142:145]
  v_mfma_f32_16x16x32_bf16 v[162:165], v[58:61], v[94:97], v[162:165]
  v_mfma_f32_16x16x32_bf16 v[186:189], v[62:65], v[62:65], v[186:189]
  v_mfma_f32_16x16x32_bf16 v[126:129], v[86:89], v[62:65], v[126:129]
  v_mfma_f32_16x16x32_bf16 v[146:149], v[90:93], v[62:65], v[146:149]
  v_mfma_f32_16x16x32_bf16 v[166:169], v[62:65], v[94:97], v[166:169]
  s_waitcnt lgkmcnt(0)
  s_waitcnt vmcnt(9)
  s_barrier
  v_mfma_f32_16x16x32_bf16 v[110:113], v[98:101], v[66:69], v[110:113]
  ds_read_b64_tr_b16 v[86:87], v199 offset:0
  s_xor_b32 s54, s51, 768
  v_mfma_f32_16x16x32_bf16 v[130:133], v[102:105], v[66:69], v[130:133]
  ds_read_b64_tr_b16 v[88:89], v199 offset:512
  s_mul_i32 s55, s54, 1536
  v_mfma_f32_16x16x32_bf16 v[150:153], v[66:69], v[106:109], v[150:153]
  ds_read_b64_tr_b16 v[90:91], v199 offset:1024
  s_add_u32 m0, s44, 114688
  v_mfma_f32_16x16x32_bf16 v[114:117], v[98:101], v[70:73], v[114:117]
  ds_read_b64_tr_b16 v[92:93], v199 offset:1536
  buffer_load_dwordx4 v33, s[4:7], s54 offen offset:0 lds
  v_mfma_f32_16x16x32_bf16 v[134:137], v[102:105], v[70:73], v[134:137]
  ds_read_b64_tr_b16 v[94:95], v199 offset:2048
  v_mfma_f32_16x16x32_bf16 v[154:157], v[70:73], v[106:109], v[154:157]
  ds_read_b64_tr_b16 v[96:97], v199 offset:2560
  v_mfma_f32_16x16x32_bf16 v[118:121], v[98:101], v[74:77], v[118:121]
  ds_read_b128 v[46:49], v197 offset:20480
  buffer_load_dwordx4 v37, s[8:11], s55 offen offset:1024 lds
  v_mfma_f32_16x16x32_bf16 v[138:141], v[102:105], v[74:77], v[138:141]
  ds_read_b128 v[50:53], v45 offset:16384
  v_mfma_f32_16x16x32_bf16 v[158:161], v[74:77], v[106:109], v[158:161]
  ds_read_b128 v[54:57], v45 offset:24576
  v_mfma_f32_16x16x32_bf16 v[122:125], v[98:101], v[78:81], v[122:125]
  ds_read_b128 v[58:61], v45 offset:3072
  buffer_load_dwordx4 v37, s[8:11], s55 offen offset:2048 lds
  v_mfma_f32_16x16x32_bf16 v[142:145], v[102:105], v[78:81], v[142:145]
  ds_read_b128 v[62:65], v45 offset:11264
  v_mfma_f32_16x16x32_bf16 v[162:165], v[78:81], v[106:109], v[162:165]
  v_mfma_f32_16x16x32_bf16 v[126:129], v[98:101], v[82:85], v[126:129]
  buffer_load_dwordx4 v37, s[8:11], s55 offen offset:3072 lds
  s_add_u32 m0, s44, 98304
  v_mfma_f32_16x16x32_bf16 v[146:149], v[102:105], v[82:85], v[146:149]
  v_mfma_f32_16x16x32_bf16 v[166:169], v[82:85], v[106:109], v[166:169]
  s_waitcnt lgkmcnt(3)
  v_mfma_f32_16x16x32_bf16 v[170:173], v[46:49], v[46:49], v[170:173]
  ds_read_b64_tr_b16 v[98:99], v200 offset:0
  buffer_load_dwordx4 v34, s[4:7], s54 offen offset:3072 lds
  v_mfma_f32_16x16x32_bf16 v[110:113], v[86:89], v[46:49], v[110:113]
  ds_read_b64_tr_b16 v[100:101], v200 offset:512
  v_mfma_f32_16x16x32_bf16 v[130:133], v[90:93], v[46:49], v[130:133]
  ds_read_b64_tr_b16 v[102:103], v200 offset:1024
  v_mfma_f32_16x16x32_bf16 v[150:153], v[46:49], v[94:97], v[150:153]
  ds_read_b64_tr_b16 v[104:105], v200 offset:1536
  buffer_load_dwordx4 v36, s[8:11], s55 offen offset:0 lds
  v_mfma_f32_16x16x32_bf16 v[174:177], v[50:53], v[50:53], v[174:177]
  ds_read_b64_tr_b16 v[106:107], v200 offset:2048
  v_mfma_f32_16x16x32_bf16 v[114:117], v[86:89], v[50:53], v[114:117]
  ds_read_b64_tr_b16 v[108:109], v200 offset:2560
  v_mfma_f32_16x16x32_bf16 v[134:137], v[90:93], v[50:53], v[134:137]
  ds_read_b128 v[66:69], v198 offset:20480
  buffer_load_dwordx4 v36, s[8:11], s55 offen offset:1024 lds
  v_mfma_f32_16x16x32_bf16 v[154:157], v[50:53], v[94:97], v[154:157]
  ds_read_b128 v[70:73], v194 offset:16384
  s_waitcnt lgkmcnt(8)
  v_mfma_f32_16x16x32_bf16 v[178:181], v[54:57], v[54:57], v[178:181]
  ds_read_b128 v[74:77], v194 offset:24576
  v_mfma_f32_16x16x32_bf16 v[118:121], v[86:89], v[54:57], v[118:121]
  ds_read_b128 v[78:81], v194 offset:3072
  buffer_load_dwordx4 v36, s[8:11], s55 offen offset:2048 lds
  v_mfma_f32_16x16x32_bf16 v[138:141], v[90:93], v[54:57], v[138:141]
  ds_read_b128 v[82:85], v194 offset:11264
  v_mfma_f32_16x16x32_bf16 v[158:161], v[54:57], v[94:97], v[158:161]
  v_mfma_f32_16x16x32_bf16 v[182:185], v[58:61], v[58:61], v[182:185]
  v_mfma_f32_16x16x32_bf16 v[122:125], v[86:89], v[58:61], v[122:125]
  v_mfma_f32_16x16x32_bf16 v[142:145], v[90:93], v[58:61], v[142:145]
  v_mfma_f32_16x16x32_bf16 v[162:165], v[58:61], v[94:97], v[162:165]
  v_mfma_f32_16x16x32_bf16 v[186:189], v[62:65], v[62:65], v[186:189]
  v_mfma_f32_16x16x32_bf16 v[126:129], v[86:89], v[62:65], v[126:129]
  v_mfma_f32_16x16x32_bf16 v[146:149], v[90:93], v[62:65], v[146:149]
  v_mfma_f32_16x16x32_bf16 v[166:169], v[62:65], v[94:97], v[166:169]
  s_waitcnt lgkmcnt(0)
  s_waitcnt vmcnt(9)
  s_barrier
  v_mfma_f32_16x16x32_bf16 v[110:113], v[98:101], v[66:69], v[110:113]
  ds_read_b64_tr_b16 v[86:87], v199 offset:32768
  s_xor_b32 s54, s51, 896
  v_mfma_f32_16x16x32_bf16 v[130:133], v[102:105], v[66:69], v[130:133]
  ds_read_b64_tr_b16 v[88:89], v199 offset:33280
  s_mul_i32 s55, s54, 1536
  v_mfma_f32_16x16x32_bf16 v[150:153], v[66:69], v[106:109], v[150:153]
  ds_read_b64_tr_b16 v[90:91], v199 offset:33792
  s_add_u32 m0, s44, 147456
  v_mfma_f32_16x16x32_bf16 v[114:117], v[98:101], v[70:73], v[114:117]
  ds_read_b64_tr_b16 v[92:93], v199 offset:34304
  buffer_load_dwordx4 v33, s[4:7], s54 offen offset:0 lds
  v_mfma_f32_16x16x32_bf16 v[134:137], v[102:105], v[70:73], v[134:137]
  ds_read_b64_tr_b16 v[94:95], v199 offset:34816
  v_mfma_f32_16x16x32_bf16 v[154:157], v[70:73], v[106:109], v[154:157]
  ds_read_b64_tr_b16 v[96:97], v199 offset:35328
  v_mfma_f32_16x16x32_bf16 v[118:121], v[98:101], v[74:77], v[118:121]
  ds_read_b128 v[46:49], v197 offset:21504
  buffer_load_dwordx4 v37, s[8:11], s55 offen offset:1024 lds
  v_mfma_f32_16x16x32_bf16 v[138:141], v[102:105], v[74:77], v[138:141]
  ds_read_b128 v[50:53], v45 offset:49152
  v_mfma_f32_16x16x32_bf16 v[158:161], v[74:77], v[106:109], v[158:161]
  ds_read_b128 v[54:57], v45 offset:57344
  v_mfma_f32_16x16x32_bf16 v[122:125], v[98:101], v[78:81], v[122:125]
  ds_read_b128 v[58:61], v45 offset:35840
  buffer_load_dwordx4 v37, s[8:11], s55 offen offset:2048 lds
  v_mfma_f32_16x16x32_bf16 v[142:145], v[102:105], v[78:81], v[142:145]
  ds_read_b128 v[62:65], v45 offset:44032
  v_mfma_f32_16x16x32_bf16 v[162:165], v[78:81], v[106:109], v[162:165]
  v_mfma_f32_16x16x32_bf16 v[126:129], v[98:101], v[82:85], v[126:129]
  buffer_load_dwordx4 v37, s[8:11], s55 offen offset:3072 lds
  s_add_u32 m0, s44, 131072
  v_mfma_f32_16x16x32_bf16 v[146:149], v[102:105], v[82:85], v[146:149]
  v_mfma_f32_16x16x32_bf16 v[166:169], v[82:85], v[106:109], v[166:169]
  s_waitcnt lgkmcnt(3)
  v_mfma_f32_16x16x32_bf16 v[170:173], v[46:49], v[46:49], v[170:173]
  ds_read_b64_tr_b16 v[98:99], v200 offset:32768
  buffer_load_dwordx4 v34, s[4:7], s54 offen offset:3072 lds
  v_mfma_f32_16x16x32_bf16 v[110:113], v[86:89], v[46:49], v[110:113]
  ds_read_b64_tr_b16 v[100:101], v200 offset:33280
  v_mfma_f32_16x16x32_bf16 v[130:133], v[90:93], v[46:49], v[130:133]
  ds_read_b64_tr_b16 v[102:103], v200 offset:33792
  v_mfma_f32_16x16x32_bf16 v[150:153], v[46:49], v[94:97], v[150:153]
  ds_read_b64_tr_b16 v[104:105], v200 offset:34304
  buffer_load_dwordx4 v36, s[8:11], s55 offen offset:0 lds
  v_mfma_f32_16x16x32_bf16 v[174:177], v[50:53], v[50:53], v[174:177]
  ds_read_b64_tr_b16 v[106:107], v200 offset:34816
  v_mfma_f32_16x16x32_bf16 v[114:117], v[86:89], v[50:53], v[114:117]
  ds_read_b64_tr_b16 v[108:109], v200 offset:35328
  v_mfma_f32_16x16x32_bf16 v[134:137], v[90:93], v[50:53], v[134:137]
  ds_read_b128 v[66:69], v198 offset:21504
  buffer_load_dwordx4 v36, s[8:11], s55 offen offset:1024 lds
  v_mfma_f32_16x16x32_bf16 v[154:157], v[50:53], v[94:97], v[154:157]
  ds_read_b128 v[70:73], v194 offset:49152
  s_waitcnt lgkmcnt(8)
  v_mfma_f32_16x16x32_bf16 v[178:181], v[54:57], v[54:57], v[178:181]
  ds_read_b128 v[74:77], v194 offset:57344
  v_mfma_f32_16x16x32_bf16 v[118:121], v[86:89], v[54:57], v[118:121]
  ds_read_b128 v[78:81], v194 offset:35840
  buffer_load_dwordx4 v36, s[8:11], s55 offen offset:2048 lds
  v_mfma_f32_16x16x32_bf16 v[138:141], v[90:93], v[54:57], v[138:141]
  ds_read_b128 v[82:85], v194 offset:44032
  s_add_u32 m0, s44, 32768
  v_mfma_f32_16x16x32_bf16 v[158:161], v[54:57], v[94:97], v[158:161]
  s_mov_b32 s62, 0
  v_mfma_f32_16x16x32_bf16 v[182:185], v[58:61], v[58:61], v[182:185]
  buffer_load_dwordx4 v223, s[12:15], s62 offen offset:0 lds
  v_mfma_f32_16x16x32_bf16 v[122:125], v[86:89], v[58:61], v[122:125]
  v_mfma_f32_16x16x32_bf16 v[142:145], v[90:93], v[58:61], v[142:145]
  v_mfma_f32_16x16x32_bf16 v[162:165], v[58:61], v[94:97], v[162:165]
  buffer_load_dwordx4 v224, s[12:15], s62 offen offset:1024 lds
  v_mfma_f32_16x16x32_bf16 v[186:189], v[62:65], v[62:65], v[186:189]
  v_mfma_f32_16x16x32_bf16 v[126:129], v[86:89], v[62:65], v[126:129]
  v_mfma_f32_16x16x32_bf16 v[146:149], v[90:93], v[62:65], v[146:149]
  buffer_load_dwordx4 v225, s[12:15], s62 offen offset:2048 lds
  v_mfma_f32_16x16x32_bf16 v[166:169], v[62:65], v[94:97], v[166:169]
  s_waitcnt lgkmcnt(0)
  s_waitcnt vmcnt(11)
  s_barrier
  v_mfma_f32_16x16x32_bf16 v[110:113], v[98:101], v[66:69], v[110:113]
  ds_read_b64_tr_b16 v[86:87], v201 offset:0
  v_mfma_f32_16x16x32_bf16 v[130:133], v[102:105], v[66:69], v[130:133]
  ds_read_b64_tr_b16 v[88:89], v201 offset:512
  buffer_load_dwordx4 v226, s[12:15], s62 offen offset:3072 lds
  v_mfma_f32_16x16x32_bf16 v[150:153], v[66:69], v[106:109], v[150:153]
  ds_read_b64_tr_b16 v[90:91], v201 offset:1024
  s_add_u32 m0, s44, 49152
  v_mfma_f32_16x16x32_bf16 v[114:117], v[98:101], v[70:73], v[114:117]
  ds_read_b64_tr_b16 v[92:93], v201 offset:1536
  s_mov_b32 s62, 131072
  v_mfma_f32_16x16x32_bf16 v[134:137], v[102:105], v[70:73], v[134:137]
  ds_read_b64_tr_b16 v[94:95], v201 offset:2048
  buffer_load_dwordx4 v223, s[12:15], s62 offen offset:0 lds
  v_mfma_f32_16x16x32_bf16 v[154:157], v[70:73], v[106:109], v[154:157]
  ds_read_b64_tr_b16 v[96:97], v201 offset:2560
  v_mfma_f32_16x16x32_bf16 v[118:121], v[98:101], v[74:77], v[118:121]
  ds_read_b128 v[46:49], v197 offset:22528
  v_mfma_f32_16x16x32_bf16 v[138:141], v[102:105], v[74:77], v[138:141]
  ds_read_b128 v[50:53], v195 offset:16384
  buffer_load_dwordx4 v224, s[12:15], s62 offen offset:1024 lds
  v_mfma_f32_16x16x32_bf16 v[158:161], v[74:77], v[106:109], v[158:161]
  ds_read_b128 v[54:57], v195 offset:24576
  v_mfma_f32_16x16x32_bf16 v[122:125], v[98:101], v[78:81], v[122:125]
  ds_read_b128 v[58:61], v195 offset:3072
  v_mfma_f32_16x16x32_bf16 v[142:145], v[102:105], v[78:81], v[142:145]
  ds_read_b128 v[62:65], v195 offset:11264
  buffer_load_dwordx4 v225, s[12:15], s62 offen offset:2048 lds
  v_mfma_f32_16x16x32_bf16 v[162:165], v[78:81], v[106:109], v[162:165]
  v_mfma_f32_16x16x32_bf16 v[126:129], v[98:101], v[82:85], v[126:129]
  v_mfma_f32_16x16x32_bf16 v[146:149], v[102:105], v[82:85], v[146:149]
  buffer_load_dwordx4 v226, s[12:15], s62 offen offset:3072 lds
  s_add_u32 m0, s44, 65536
  v_mfma_f32_16x16x32_bf16 v[166:169], v[82:85], v[106:109], v[166:169]
  s_mov_b32 s62, 262144
  s_waitcnt lgkmcnt(3)
  v_mfma_f32_16x16x32_bf16 v[170:173], v[46:49], v[46:49], v[170:173]
  ds_read_b64_tr_b16 v[98:99], v202 offset:0
  v_mfma_f32_16x16x32_bf16 v[110:113], v[86:89], v[46:49], v[110:113]
  ds_read_b64_tr_b16 v[100:101], v202 offset:512
  buffer_load_dwordx4 v223, s[12:15], s62 offen offset:0 lds
  v_mfma_f32_16x16x32_bf16 v[130:133], v[90:93], v[46:49], v[130:133]
  ds_read_b64_tr_b16 v[102:103], v202 offset:1024
  v_mfma_f32_16x16x32_bf16 v[150:153], v[46:49], v[94:97], v[150:153]
  ds_read_b64_tr_b16 v[104:105], v202 offset:1536
  v_mfma_f32_16x16x32_bf16 v[174:177], v[50:53], v[50:53], v[174:177]
  ds_read_b64_tr_b16 v[106:107], v202 offset:2048
  buffer_load_dwordx4 v224, s[12:15], s62 offen offset:1024 lds
  v_mfma_f32_16x16x32_bf16 v[114:117], v[86:89], v[50:53], v[114:117]
  ds_read_b64_tr_b16 v[108:109], v202 offset:2560
  v_mfma_f32_16x16x32_bf16 v[134:137], v[90:93], v[50:53], v[134:137]
  ds_read_b128 v[66:69], v198 offset:22528
  v_mfma_f32_16x16x32_bf16 v[154:157], v[50:53], v[94:97], v[154:157]
  ds_read_b128 v[70:73], v196 offset:16384
  s_waitcnt lgkmcnt(8)
  v_mfma_f32_16x16x32_bf16 v[178:181], v[54:57], v[54:57], v[178:181]
  ds_read_b128 v[74:77], v196 offset:24576
  buffer_load_dwordx4 v225, s[12:15], s62 offen offset:2048 lds
  v_mfma_f32_16x16x32_bf16 v[118:121], v[86:89], v[54:57], v[118:121]
  ds_read_b128 v[78:81], v196 offset:3072
  v_mfma_f32_16x16x32_bf16 v[138:141], v[90:93], v[54:57], v[138:141]
  ds_read_b128 v[82:85], v196 offset:11264
  v_mfma_f32_16x16x32_bf16 v[158:161], v[54:57], v[94:97], v[158:161]
  buffer_load_dwordx4 v226, s[12:15], s62 offen offset:3072 lds
  s_add_u32 m0, s44, 81920
  v_mfma_f32_16x16x32_bf16 v[182:185], v[58:61], v[58:61], v[182:185]
  s_mov_b32 s62, 393216
  v_mfma_f32_16x16x32_bf16 v[122:125], v[86:89], v[58:61], v[122:125]
  v_mfma_f32_16x16x32_bf16 v[142:145], v[90:93], v[58:61], v[142:145]
  buffer_load_dwordx4 v223, s[12:15], s62 offen offset:0 lds
  v_mfma_f32_16x16x32_bf16 v[162:165], v[58:61], v[94:97], v[162:165]
  v_mfma_f32_16x16x32_bf16 v[186:189], v[62:65], v[62:65], v[186:189]
  v_mfma_f32_16x16x32_bf16 v[126:129], v[86:89], v[62:65], v[126:129]
  buffer_load_dwordx4 v224, s[12:15], s62 offen offset:1024 lds
  v_mfma_f32_16x16x32_bf16 v[146:149], v[90:93], v[62:65], v[146:149]
  v_mfma_f32_16x16x32_bf16 v[166:169], v[62:65], v[94:97], v[166:169]
  s_waitcnt lgkmcnt(0)
  s_waitcnt vmcnt(14)
  s_barrier
  v_mfma_f32_16x16x32_bf16 v[110:113], v[98:101], v[66:69], v[110:113]
  ds_read_b64_tr_b16 v[86:87], v201 offset:32768
  buffer_load_dwordx4 v225, s[12:15], s62 offen offset:2048 lds
  v_mfma_f32_16x16x32_bf16 v[130:133], v[102:105], v[66:69], v[130:133]
  ds_read_b64_tr_b16 v[88:89], v201 offset:33280
  v_mfma_f32_16x16x32_bf16 v[150:153], v[66:69], v[106:109], v[150:153]
  ds_read_b64_tr_b16 v[90:91], v201 offset:33792
  v_mfma_f32_16x16x32_bf16 v[114:117], v[98:101], v[70:73], v[114:117]
  ds_read_b64_tr_b16 v[92:93], v201 offset:34304
  buffer_load_dwordx4 v226, s[12:15], s62 offen offset:3072 lds
  v_mfma_f32_16x16x32_bf16 v[134:137], v[102:105], v[70:73], v[134:137]
  ds_read_b64_tr_b16 v[94:95], v201 offset:34816
  v_mfma_f32_16x16x32_bf16 v[154:157], v[70:73], v[106:109], v[154:157]
  ds_read_b64_tr_b16 v[96:97], v201 offset:35328
  v_mfma_f32_16x16x32_bf16 v[118:121], v[98:101], v[74:77], v[118:121]
  ds_read_b128 v[46:49], v197 offset:23552
  buffer_load_dword v5, v10, s[24:27], 0 offen
  v_mfma_f32_16x16x32_bf16 v[138:141], v[102:105], v[74:77], v[138:141]
  ds_read_b128 v[50:53], v195 offset:49152
  v_mfma_f32_16x16x32_bf16 v[158:161], v[74:77], v[106:109], v[158:161]
  ds_read_b128 v[54:57], v195 offset:57344
  v_mfma_f32_16x16x32_bf16 v[122:125], v[98:101], v[78:81], v[122:125]
  ds_read_b128 v[58:61], v195 offset:35840
  buffer_load_dword v5, v10, s[24:27], s63 offen
  v_mfma_f32_16x16x32_bf16 v[142:145], v[102:105], v[78:81], v[142:145]
  ds_read_b128 v[62:65], v195 offset:44032
  v_mfma_f32_16x16x32_bf16 v[162:165], v[78:81], v[106:109], v[162:165]
  v_mfma_f32_16x16x32_bf16 v[126:129], v[98:101], v[82:85], v[126:129]
  buffer_load_dword v5, v11, s[24:27], 0 offen
  v_mfma_f32_16x16x32_bf16 v[146:149], v[102:105], v[82:85], v[146:149]
  v_mfma_f32_16x16x32_bf16 v[166:169], v[82:85], v[106:109], v[166:169]
  s_waitcnt lgkmcnt(4)
  v_mfma_f32_16x16x32_bf16 v[110:113], v[86:89], v[46:49], v[110:113]
  ds_read_b64_tr_b16 v[98:99], v202 offset:32768
  buffer_load_dword v5, v9, s[96:99], 0 offen
  v_add_u32 v9, 262144, v9
  v_mfma_f32_16x16x32_bf16 v[130:133], v[90:93], v[46:49], v[130:133]
  ds_read_b64_tr_b16 v[100:101], v202 offset:33280
  v_mfma_f32_16x16x32_bf16 v[150:153], v[46:49], v[94:97], v[150:153]
  ds_read_b64_tr_b16 v[102:103], v202 offset:33792
  v_mfma_f32_16x16x32_bf16 v[170:173], v[46:49], v[46:49], v[170:173]
  ds_read_b64_tr_b16 v[104:105], v202 offset:34304
  s_waitcnt lgkmcnt(4)
  v_mfma_f32_16x16x32_bf16 v[174:177], v[50:53], v[50:53], v[174:177]
  ds_read_b64_tr_b16 v[106:107], v202 offset:34816
  global_load_dword v5, v3, s[32:33]
  v_mfma_f32_16x16x32_bf16 v[178:181], v[54:57], v[54:57], v[178:181]
  ds_read_b64_tr_b16 v[108:109], v202 offset:35328
  v_mfma_f32_16x16x32_bf16 v[182:185], v[58:61], v[58:61], v[182:185]
  ds_read_b128 v[66:69], v198 offset:23552
  v_mfma_f32_16x16x32_bf16 v[186:189], v[62:65], v[62:65], v[186:189]
  ds_read_b128 v[70:73], v196 offset:49152
  global_load_dword v5, v4, s[34:35]
  v_mfma_f32_16x16x32_bf16 v[114:117], v[86:89], v[50:53], v[114:117]
  ds_read_b128 v[74:77], v196 offset:57344
  s_add_u32 m0, s44, 98304
  v_mfma_f32_16x16x32_bf16 v[134:137], v[90:93], v[50:53], v[134:137]
  ds_read_b128 v[78:81], v196 offset:35840
  v_mfma_f32_16x16x32_bf16 v[154:157], v[50:53], v[94:97], v[154:157]
  ds_read_b128 v[82:85], v196 offset:44032
  buffer_load_dwordx4 v15, s[16:19], s57 offen offset:0 lds
  v_mfma_f32_16x16x32_bf16 v[118:121], v[86:89], v[54:57], v[118:121]
  v_mfma_f32_16x16x32_bf16 v[138:141], v[90:93], v[54:57], v[138:141]
  v_cndmask_b32 v229, v170, v171, s[66:67]
  v_cndmask_b32 v229, v229, v172, s[68:69]
  v_cndmask_b32 v229, v229, v173, s[70:71]
  v_mfma_f32_16x16x32_bf16 v[158:161], v[54:57], v[94:97], v[158:161]
  v_cndmask_b32 v230, v174, v175, s[66:67]
  v_cndmask_b32 v230, v230, v176, s[68:69]
  v_cndmask_b32 v230, v230, v177, s[70:71]
  v_mfma_f32_16x16x32_bf16 v[122:125], v[86:89], v[58:61], v[122:125]
  v_cndmask_b32 v231, v178, v179, s[66:67]
  v_cndmask_b32 v231, v231, v180, s[68:69]
  v_cndmask_b32 v231, v231, v181, s[70:71]
  v_mfma_f32_16x16x32_bf16 v[142:145], v[90:93], v[58:61], v[142:145]
  v_cndmask_b32 v232, v182, v183, s[66:67]
  v_cndmask_b32 v232, v232, v184, s[68:69]
  v_cndmask_b32 v232, v232, v185, s[70:71]
  v_mfma_f32_16x16x32_bf16 v[162:165], v[58:61], v[94:97], v[162:165]
  v_cndmask_b32 v233, v186, v187, s[66:67]
  v_cndmask_b32 v233, v233, v188, s[68:69]
  v_cndmask_b32 v233, v233, v189, s[70:71]
  v_mfma_f32_16x16x32_bf16 v[126:129], v[86:89], v[62:65], v[126:129]
  ds_write_b32 v203, v229 offset:16384
  ds_write_b32 v203, v230 offset:16640
  v_mfma_f32_16x16x32_bf16 v[146:149], v[90:93], v[62:65], v[146:149]
  ds_write_b32 v203, v231 offset:16896
  ds_write_b32 v203, v232 offset:17152
  v_mfma_f32_16x16x32_bf16 v[166:169], v[62:65], v[94:97], v[166:169]
  ds_write_b32 v203, v233 offset:17408
  buffer_load_dwordx4 v16, s[16:19], s57 offen offset:1024 lds
  s_branch L_loopE
L_idle:
  s_waitcnt lgkmcnt(0)
  buffer_load_dword v5, v9, s[96:99], 0 offen
  v_add_u32 v9, 262144, v9
  buffer_load_dword v5, v9, s[96:99], 0 offen
  v_add_u32 v9, 262144, v9
  buffer_load_dword v5, v9, s[96:99], 0 offen
  v_add_u32 v9, 262144, v9
  buffer_load_dword v5, v9, s[96:99], 0 offen
  v_add_u32 v9, 262144, v9
  buffer_load_dword v5, v9, s[96:99], 0 offen
  v_add_u32 v9, 262144, v9
  buffer_load_dword v5, v9, s[96:99], 0 offen
  v_add_u32 v9, 262144, v9
  v_bfe_u32 v2, v6, 1, 4
  v_and_b32 v1, 14, v2
  v_lshrrev_b32 v3, 5, v6
  v_and_b32 v4, 1, v6
  v_xor_b32 v1, v1, v3
  v_xor_b32 v1, v1, v4
  v_lshlrev_b32 v1, 3, v1
  s_lshl_b32 s41, s51, 6
  s_add_u32 s41, s41, s52
  v_xor_b32 v1, s41, v1
  v_lshl_add_u32 v1, v2, 7, v1
  v_lshl_add_u32 v1, v4, 13, v1
  ds_read_b64 v[48:49], v1 offset:2048
  v_xor_b32 v2, 16, v1
  ds_read_b64 v[50:51], v2 offset:2048
  v_xor_b32 v2, 32, v1
  ds_read_b64 v[52:53], v2 offset:2048
  v_xor_b32 v2, 48, v1
  ds_read_b64 v[54:55], v2 offset:2048
  v_lshl_add_u32 v10, v6, 4, s44
  v_xor_b32 v11, 8192, v10
  s_lshl3_add_u32 s41, s65, s38
  s_lshl_b32 s41, s41, 11
  v_lshl_add_u32 v12, v6, 4, s41
  v_xor_b32 v13, 2048, v12
  s_lshl_b32 s49, s52, 6
  s_xor_b32 s41, s38, 1
  s_lshl2_add_u32 s41, s41, s48
  s_mul_i32 s41, s41, 57344
  s_add_u32 s41, s41, 4194304
  v_lshrrev_b32 v1, 2, v6
  v_min_u32 v1, 13, v1
  v_or_b32 v1, 1, v1
  v_lshl_add_u32 v31, v1, 12, s41
  v_and_b32 v1, 3, v6
  v_lshl_add_u32 v31, v1, 4, v31
  v_add_u32 v31, 2048, v31
  s_lshl_b32 s42, s52, 4
  s_add_u32 s41, s41, s42
  v_lshl_add_u32 v30, v6, 4, s41
  s_bitcmp1_b32 s38, 0
  s_cselect_b32 s41, 1, -1
  s_mul_i32 s41, s41, 229376
  v_add_u32 v14, s41, v30
  s_lshl_b32 s41, s37, 16
  s_lshl_b32 s42, s38, 7
  s_add_u32 s41, s41, s42
  s_add_u32 s41, s41, s52
  v_lshl_add_u32 v34, v46, 10, s41
  v_lshl_add_u32 v34, v3, 4, v34
  s_min_u32 s41, s2, 1
  s_lshl_b32 s41, s41, 23
  s_add_u32 s41, s41, 6819840
  v_lshl_add_u32 v36, v0, 23, s41
  v_mov_b32 v37, s46
  s_waitcnt lgkmcnt(0)
  v_lshlrev_b32 v33, 16, v33
  v_mul_f32 v33, s50, v33
  v_lshlrev_b32 v240, 16, v48
  v_and_b32 v241, 0xffff0000, v48
  v_lshlrev_b32 v242, 16, v49
  v_and_b32 v243, 0xffff0000, v49
  v_lshlrev_b32 v244, 16, v50
  v_and_b32 v245, 0xffff0000, v50
  v_lshlrev_b32 v246, 16, v51
  v_and_b32 v247, 0xffff0000, v51
  v_lshlrev_b32 v248, 16, v52
  v_and_b32 v249, 0xffff0000, v52
  v_lshlrev_b32 v250, 16, v53
  v_and_b32 v251, 0xffff0000, v53
  v_lshlrev_b32 v252, 16, v54
  v_and_b32 v253, 0xffff0000, v54
  v_lshlrev_b32 v254, 16, v55
  v_and_b32 v255, 0xffff0000, v55
  s_mov_b32 s41, 0x24800000
  v_fma_f32 v240, v240, s41, v33
  v_fma_f32 v241, v241, s41, v33
  v_fma_f32 v242, v242, s41, v33
  v_fma_f32 v243, v243, s41, v33
  v_fma_f32 v244, v244, s41, v33
  v_fma_f32 v245, v245, s41, v33
  v_fma_f32 v246, v246, s41, v33
  v_fma_f32 v247, v247, s41, v33
  v_fma_f32 v248, v248, s41, v33
  v_fma_f32 v249, v249, s41, v33
  v_fma_f32 v250, v250, s41, v33
  v_fma_f32 v251, v251, s41, v33
  v_fma_f32 v252, v252, s41, v33
  v_fma_f32 v253, v253, s41, v33
  v_fma_f32 v254, v254, s41, v33
  v_fma_f32 v255, v255, s41, v33
  s_barrier
  s_waitcnt vmcnt(0)
  s_and_b32 s41, s2, 7
  s_lshl_b32 s41, s41, 7
  s_add_u32 s41, s41, 6816768
  v_mov_b32 v3, s41
  s_mov_b32 s42, 0
  s_add_u32 m0, s44, 114688
  s_mov_b32 s45, 0
  buffer_load_dwordx4 v72, s[20:23], s45 offen offset:0 lds
  buffer_load_dwordx4 v73, s[20:23], s45 offen offset:1024 lds
  buffer_load_dwordx4 v74, s[20:23], s45 offen offset:2048 lds
  buffer_load_dwordx4 v75, s[20:23], s45 offen offset:3072 lds
  s_add_u32 m0, s44, 65536
  s_mov_b32 s45, 262144
  buffer_load_dwordx4 v72, s[20:23], s45 offen offset:0 lds
  buffer_load_dwordx4 v73, s[20:23], s45 offen offset:1024 lds
  buffer_load_dwordx4 v74, s[20:23], s45 offen offset:2048 lds
  buffer_load_dwordx4 v75, s[20:23], s45 offen offset:3072 lds
  s_add_u32 m0, s44, 81920
  s_mov_b32 s45, 524288
  buffer_load_dwordx4 v72, s[20:23], s45 offen offset:0 lds
  buffer_load_dwordx4 v73, s[20:23], s45 offen offset:1024 lds
  buffer_load_dwordx4 v74, s[20:23], s45 offen offset:2048 lds
  buffer_load_dwordx4 v75, s[20:23], s45 offen offset:3072 lds
  s_add_u32 m0, s44, 131072
  s_mov_b32 s45, 786432
  buffer_load_dwordx4 v72, s[20:23], s45 offen offset:0 lds
  buffer_load_dwordx4 v73, s[20:23], s45 offen offset:1024 lds
  buffer_load_dwordx4 v74, s[20:23], s45 offen offset:2048 lds
  buffer_load_dwordx4 v75, s[20:23], s45 offen offset:3072 lds
  buffer_load_dword v4, v3, s[24:27], 0 offen sc1
  s_add_u32 m0, s44, 147456
  s_mov_b32 s45, 1048576
  buffer_load_dwordx4 v72, s[20:23], s45 offen offset:0 lds
  buffer_load_dwordx4 v73, s[20:23], s45 offen offset:1024 lds
  buffer_load_dwordx4 v74, s[20:23], s45 offen offset:2048 lds
  buffer_load_dwordx4 v75, s[20:23], s45 offen offset:3072 lds
  s_add_u32 m0, s44, 16384
  s_mov_b32 s45, 1310720
  buffer_load_dwordx4 v72, s[20:23], s45 offen offset:0 lds
  buffer_load_dwordx4 v73, s[20:23], s45 offen offset:1024 lds
  buffer_load_dwordx4 v74, s[20:23], s45 offen offset:2048 lds
  buffer_load_dwordx4 v75, s[20:23], s45 offen offset:3072 lds
  s_add_u32 m0, s44, 32768
  s_mov_b32 s45, 1572864
  buffer_load_dwordx4 v72, s[20:23], s45 offen offset:0 lds
  buffer_load_dwordx4 v73, s[20:23], s45 offen offset:1024 lds
  buffer_load_dwordx4 v74, s[20:23], s45 offen offset:2048 lds
  buffer_load_dwordx4 v75, s[20:23], s45 offen offset:3072 lds
  s_waitcnt vmcnt(25)
  ds_read_b64_tr_b16 a[0:1], v21 offset:49152
  ds_read_b64_tr_b16 a[2:3], v21 offset:50176
  ds_read_b64_tr_b16 a[4:5], v22 offset:49152
  ds_read_b64_tr_b16 a[6:7], v22 offset:50176
  ds_read_b64_tr_b16 a[8:9], v21 offset:51200
  ds_read_b64_tr_b16 a[10:11], v21 offset:52224
  ds_read_b64_tr_b16 a[12:13], v22 offset:51200
  ds_read_b64_tr_b16 a[14:15], v22 offset:52224
  s_waitcnt vmcnt(21)
  s_barrier
  ds_read_b64_tr_b16 a[16:17], v47 offset:49152
  ds_read_b64_tr_b16 a[18:19], v47 offset:50176
  ds_read_b64_tr_b16 a[20:21], v68 offset:49152
  ds_read_b64_tr_b16 a[22:23], v68 offset:50176
  ds_read_b64_tr_b16 a[24:25], v47 offset:51200
  ds_read_b64_tr_b16 a[26:27], v47 offset:52224
  ds_read_b64_tr_b16 a[28:29], v68 offset:51200
  ds_read_b64_tr_b16 a[30:31], v68 offset:52224
  s_waitcnt vmcnt(12)
  v_xor_b32 v4, s46, v4
  v_cmp_gt_u32 vcc, 16, v4
  s_cbranch_vccnz L_join
L_hint:
  buffer_load_dword v4, v3, s[24:27], 0 offen sc1
  s_add_u32 s42, s42, 1
  s_waitcnt vmcnt(0)
  v_xor_b32 v4, s46, v4
  v_cmp_gt_u32 vcc, 16, v4
  s_cbranch_vccnz L_hint_ok
  s_cmp_lt_u32 s42, 12
  s_cbranch_scc1 L_hint
L_hint_ok:
  s_waitcnt vmcnt(0)
  s_waitcnt lgkmcnt(0)
  s_branch L_join
L_p3p16:
  buffer_load_dwordx2 v[56:57], v39, s[24:27], 0 offen sc1
  s_xor_b32 s53, s61, 0
  buffer_load_dwordx4 v[160:163], v38, s[24:27], s53 offen offset:0 sc1
  buffer_load_dwordx4 v[164:167], v38, s[24:27], s53 offen offset:2048 sc1
  s_xor_b32 s53, s61, 4096
  buffer_load_dwordx4 v[168:171], v38, s[24:27], s53 offen offset:0 sc1
  buffer_load_dwordx4 v[172:175], v38, s[24:27], s53 offen offset:2048 sc1
  s_xor_b32 s53, s61, 8192
  buffer_load_dwordx4 v[176:179], v38, s[24:27], s53 offen offset:0 sc1
  buffer_load_dwordx4 v[180:183], v38, s[24:27], s53 offen offset:2048 sc1
  s_xor_b32 s53, s61, 12288
  buffer_load_dwordx4 v[184:187], v38, s[24:27], s53 offen offset:0 sc1
  buffer_load_dwordx4 v[188:191], v38, s[24:27], s53 offen offset:2048 sc1
  s_xor_b32 s53, s61, 16384
  buffer_load_dwordx4 v[192:195], v38, s[24:27], s53 offen offset:0 sc1
  buffer_load_dwordx4 v[196:199], v38, s[24:27], s53 offen offset:2048 sc1
  s_waitcnt vmcnt(10)
  v_lshl_add_u64 v[56:57], v[56:57], 0, v[28:29]
  v_bitop3_b32 v41, v56, v57, s81 bitop3:0xa8
  v_cmp_ne_u32 vcc, 0, v41
  s_cbranch_vccz L_p3p16_k
  s_add_u32 s43, s43, 1
  s_cmp_lt_u32 s43, 30000
  s_cbranch_scc1 L_p3p16
L_p3p16_k:
  s_branch L_p3p16_b
L_sl51:
  buffer_load_dwordx4 v[120:123], v13, s[24:27], 0 offen offset:0 sc1
  buffer_load_dwordx4 v[124:127], v13, s[24:27], 0 offen offset:1024 sc1
  s_waitcnt vmcnt(0)
  v_lshl_add_u64 v[120:121], v[120:121], 0, v[62:63]
  v_lshl_add_u64 v[124:125], v[124:125], 0, v[62:63]
  v_or3_b32 v44, v120, v121, v124
  v_bitop3_b32 v44, v44, v125, s81 bitop3:0xa8
  v_cmp_ne_u32 vcc, 0, v44
  s_cbranch_vccz L_sl51_b
  s_add_u32 s43, s43, 1
  s_cmp_lt_u32 s43, 30000
  s_cbranch_scc1 L_sl51
  s_branch L_sl51_b
L_p4p52:
  buffer_load_dwordx2 v[56:57], v31, s[24:27], 0 offen sc1
  s_xor_b32 s53, s49, 0
  buffer_load_dwordx4 v[176:179], v30, s[24:27], s53 offen offset:0 sc1
  buffer_load_dwordx4 v[180:183], v30, s[24:27], s53 offen offset:2048 sc1
  s_xor_b32 s53, s49, 4096
  buffer_load_dwordx4 v[184:187], v30, s[24:27], s53 offen offset:0 sc1
  buffer_load_dwordx4 v[188:191], v30, s[24:27], s53 offen offset:2048 sc1
  s_xor_b32 s53, s49, 8192
  buffer_load_dwordx4 v[192:195], v30, s[24:27], s53 offen offset:0 sc1
  buffer_load_dwordx4 v[196:199], v30, s[24:27], s53 offen offset:2048 sc1
  s_xor_b32 s53, s49, 12288
  buffer_load_dwordx4 v[200:203], v30, s[24:27], s53 offen offset:0 sc1
  buffer_load_dwordx4 v[204:207], v30, s[24:27], s53 offen offset:2048 sc1
  s_waitcnt vmcnt(8)
  v_lshl_add_u64 v[56:57], v[56:57], 0, v[28:29]
  v_bitop3_b32 v15, v56, v57, s81 bitop3:0xa8
  v_cmp_ne_u32 vcc, 0, v15
  s_cbranch_vccz L_p4p52_k
  s_add_u32 s43, s43, 1
  s_cmp_lt_u32 s43, 30000
  s_cbranch_scc1 L_p4p52
L_p4p52_k:
  s_branch L_p4p52_b
L_sl83:
  buffer_load_dwordx4 v[136:139], v12, s[24:27], 0 offen offset:0 sc1
  buffer_load_dwordx4 v[140:143], v12, s[24:27], 0 offen offset:1024 sc1
  s_waitcnt vmcnt(0)
  v_lshl_add_u64 v[136:137], v[136:137], 0, v[62:63]
  v_lshl_add_u64 v[140:141], v[140:141], 0, v[62:63]
  v_or3_b32 v16, v136, v137, v140
  v_bitop3_b32 v16, v16, v141, s81 bitop3:0xa8
  v_cmp_ne_u32 vcc, 0, v16
  s_cbranch_vccz L_sl83_b
  s_add_u32 s43, s43, 1
  s_cmp_lt_u32 s43, 30000
  s_cbranch_scc1 L_sl83
  s_branch L_sl83_b
L_cold:
L_ss1:
  buffer_store_dwordx4 v[130:133], v10, s[24:27], 0 offen sc1
  s_branch L_ss1_e
L_ss2:
  buffer_store_dwordx4 v[134:137], v10, s[24:27], s63 offen sc1
  s_branch L_ss2_e
L_sl5:
  s_mov_b32 s49, 0
  buffer_load_dwordx4 v[192:195], v12, s[24:27], s49 offen offset:0 sc1
  buffer_load_dwordx4 v[196:199], v12, s[24:27], s49 offen offset:1024 sc1
  s_waitcnt vmcnt(0)
  v_xor_b32 v192, v192, v26
  v_xor_b32 v193, v193, v27
  v_xor_b32 v194, v194, v28
  v_xor_b32 v195, v195, v29
  v_xor_b32 v196, v196, v26
  v_xor_b32 v197, v197, v27
  v_xor_b32 v198, v198, v28
  v_xor_b32 v199, v199, v29
  v_or3_b32 v14, v192, v193, v194
  v_or3_b32 v14, v14, v195, v196
  v_or3_b32 v14, v14, v197, v198
  v_bitop3_b32 v14, v14, v199, s81 bitop3:0xa8
  v_cmp_ne_u32 vcc, 0, v14
  s_cbranch_vccz L_sl5_b
  s_add_u32 s43, s43, 1
  s_cmp_lt_u32 s43, 30000
  s_cbranch_scc1 L_sl5
  s_branch L_sl5_b
L_sl6:
  s_mov_b32 s49, 0
  buffer_load_dwordx4 v[200:203], v12, s[24:27], s49 offen offset:2048 sc1
  buffer_load_dwordx4 v[204:207], v12, s[24:27], s49 offen offset:3072 sc1
  s_waitcnt vmcnt(0)
  v_xor_b32 v200, v200, v26
  v_xor_b32 v201, v201, v27
  v_xor_b32 v202, v202, v28
  v_xor_b32 v203, v203, v29
  v_xor_b32 v204, v204, v26
  v_xor_b32 v205, v205, v27
  v_xor_b32 v206, v206, v28
  v_xor_b32 v207, v207, v29
  v_or3_b32 v14, v200, v201, v202
  v_or3_b32 v14, v14, v203, v204
  v_or3_b32 v14, v14, v205, v206
  v_bitop3_b32 v14, v14, v207, s81 bitop3:0xa8
  v_cmp_ne_u32 vcc, 0, v14
  s_cbranch_vccz L_sl6_b
  s_add_u32 s43, s43, 1
  s_cmp_lt_u32 s43, 30000
  s_cbranch_scc1 L_sl6
  s_branch L_sl6_b
L_sl7:
  s_mov_b32 s49, 4096
  buffer_load_dwordx4 v[208:211], v12, s[24:27], s49 offen offset:0 sc1
  buffer_load_dwordx4 v[212:215], v12, s[24:27], s49 offen offset:1024 sc1
  s_waitcnt vmcnt(0)
  v_xor_b32 v208, v208, v26
  v_xor_b32 v209, v209, v27
  v_xor_b32 v210, v210, v28
  v_xor_b32 v211, v211, v29
  v_xor_b32 v212, v212, v26
  v_xor_b32 v213, v213, v27
  v_xor_b32 v214, v214, v28
  v_xor_b32 v215, v215, v29
  v_or3_b32 v14, v208, v209, v210
  v_or3_b32 v14, v14, v211, v212
  v_or3_b32 v14, v14, v213, v214
  v_bitop3_b32 v14, v14, v215, s81 bitop3:0xa8
  v_cmp_ne_u32 vcc, 0, v14
  s_cbranch_vccz L_sl7_b
  s_add_u32 s43, s43, 1
  s_cmp_lt_u32 s43, 30000
  s_cbranch_scc1 L_sl7
  s_branch L_sl7_b
L_sl8:
  s_mov_b32 s49, 4096
  buffer_load_dwordx4 v[216:219], v12, s[24:27], s49 offen offset:2048 sc1
  buffer_load_dwordx4 v[220:223], v12, s[24:27], s49 offen offset:3072 sc1
  s_waitcnt vmcnt(0)
  v_xor_b32 v216, v216, v26
  v_xor_b32 v217, v217, v27
  v_xor_b32 v218, v218, v28
  v_xor_b32 v219, v219, v29
  v_xor_b32 v220, v220, v26
  v_xor_b32 v221, v221, v27
  v_xor_b32 v222, v222, v28
  v_xor_b32 v223, v223, v29
  v_or3_b32 v14, v216, v217, v218
  v_or3_b32 v14, v14, v219, v220
  v_or3_b32 v14, v14, v221, v222
  v_bitop3_b32 v14, v14, v223, s81 bitop3:0xa8
  v_cmp_ne_u32 vcc, 0, v14
  s_cbranch_vccz L_sl8_b
  s_add_u32 s43, s43, 1
  s_cmp_lt_u32 s43, 30000
  s_cbranch_scc1 L_sl8
  s_branch L_sl8_b
L_sl9:
  s_mov_b32 s49, 8192
  buffer_load_dwordx4 v[224:227], v12, s[24:27], s49 offen offset:0 sc1
  buffer_load_dwordx4 v[228:231], v12, s[24:27], s49 offen offset:1024 sc1
  s_waitcnt vmcnt(0)
  v_xor_b32 v224, v224, v26
  v_xor_b32 v225, v225, v27
  v_xor_b32 v226, v226, v28
  v_xor_b32 v227, v227, v29
  v_xor_b32 v228, v228, v26
  v_xor_b32 v229, v229, v27
  v_xor_b32 v230, v230, v28
  v_xor_b32 v231, v231, v29
  v_or3_b32 v14, v224, v225, v226
  v_or3_b32 v14, v14, v227, v228
  v_or3_b32 v14, v14, v229, v230
  v_bitop3_b32 v14, v14, v231, s81 bitop3:0xa8
  v_cmp_ne_u32 vcc, 0, v14
  s_cbranch_vccz L_sl9_b
  s_add_u32 s43, s43, 1
  s_cmp_lt_u32 s43, 30000
  s_cbranch_scc1 L_sl9
  s_branch L_sl9_b
L_sl10:
  s_mov_b32 s49, 8192
  buffer_load_dwordx4 v[232:235], v12, s[24:27], s49 offen offset:2048 sc1
  buffer_load_dwordx4 v[236:239], v12, s[24:27], s49 offen offset:3072 sc1
  s_waitcnt vmcnt(0)
  v_xor_b32 v232, v232, v26
  v_xor_b32 v233, v233, v27
  v_xor_b32 v234, v234, v28
  v_xor_b32 v235, v235, v29
  v_xor_b32 v236, v236, v26
  v_xor_b32 v237, v237, v27
  v_xor_b32 v238, v238, v28
  v_xor_b32 v239, v239, v29
  v_or3_b32 v14, v232, v233, v234
  v_or3_b32 v14, v14, v235, v236
  v_or3_b32 v14, v14, v237, v238
  v_bitop3_b32 v14, v14, v239, s81 bitop3:0xa8
  v_cmp_ne_u32 vcc, 0, v14
  s_cbranch_vccz L_sl10_b
  s_add_u32 s43, s43, 1
  s_cmp_lt_u32 s43, 30000
  s_cbranch_scc1 L_sl10
  s_branch L_sl10_b
L_sl11:
  s_mov_b32 s49, 12288
  buffer_load_dwordx4 v[240:243], v12, s[24:27], s49 offen offset:0 sc1
  buffer_load_dwordx4 v[244:247], v12, s[24:27], s49 offen offset:1024 sc1
  s_waitcnt vmcnt(0)
  v_xor_b32 v240, v240, v26
  v_xor_b32 v241, v241, v27
  v_xor_b32 v242, v242, v28
  v_xor_b32 v243, v243, v29
  v_xor_b32 v244, v244, v26
  v_xor_b32 v245, v245, v27
  v_xor_b32 v246, v246, v28
  v_xor_b32 v247, v247, v29
  v_or3_b32 v14, v240, v241, v242
  v_or3_b32 v14, v14, v243, v244
  v_or3_b32 v14, v14, v245, v246
  v_bitop3_b32 v14, v14, v247, s81 bitop3:0xa8
  v_cmp_ne_u32 vcc, 0, v14
  s_cbranch_vccz L_sl11_b
  s_add_u32 s43, s43, 1
  s_cmp_lt_u32 s43, 30000
  s_cbranch_scc1 L_sl11
  s_branch L_sl11_b
L_sl12:
  s_mov_b32 s49, 12288
  buffer_load_dwordx4 v[248:251], v12, s[24:27], s49 offen offset:2048 sc1
  buffer_load_dwordx4 v[252:255], v12, s[24:27], s49 offen offset:3072 sc1
  s_waitcnt vmcnt(0)
  v_xor_b32 v248, v248, v26
  v_xor_b32 v249, v249, v27
  v_xor_b32 v250, v250, v28
  v_xor_b32 v251, v251, v29
  v_xor_b32 v252, v252, v26
  v_xor_b32 v253, v253, v27
  v_xor_b32 v254, v254, v28
  v_xor_b32 v255, v255, v29
  v_or3_b32 v14, v248, v249, v250
  v_or3_b32 v14, v14, v251, v252
  v_or3_b32 v14, v14, v253, v254
  v_bitop3_b32 v14, v14, v255, s81 bitop3:0xa8
  v_cmp_ne_u32 vcc, 0, v14
  s_cbranch_vccz L_sl12_b
  s_add_u32 s43, s43, 1
  s_cmp_lt_u32 s43, 30000
  s_cbranch_scc1 L_sl12
  s_branch L_sl12_b
L_ss13:
  buffer_store_dwordx3 v[64:66], v11, s[24:27], 0 offen sc1
  s_branch L_ss13_e
L_sl17:
  s_xor_b32 s56, s61, 0
  buffer_load_dwordx4 v[160:163], v38, s[24:27], s56 offen offset:0 sc1
  buffer_load_dwordx4 v[164:167], v38, s[24:27], s56 offen offset:2048 sc1
  s_waitcnt vmcnt(0)
  v_lshl_add_u64 v[160:161], v[160:161], 0, v[28:29]
  v_lshl_add_u64 v[164:165], v[164:165], 0, v[28:29]
  v_or3_b32 v41, v160, v161, v164
  v_bitop3_b32 v41, v41, v165, s81 bitop3:0xa8
  v_cmp_ne_u32 vcc, 0, v41
  s_cbranch_vccz L_sl17_b
  s_add_u32 s43, s43, 1
  s_cmp_lt_u32 s43, 30000
  s_cbranch_scc1 L_sl17
  s_branch L_sl17_b
L_sl18:
  s_xor_b32 s56, s61, 4096
  buffer_load_dwordx4 v[168:171], v38, s[24:27], s56 offen offset:0 sc1
  buffer_load_dwordx4 v[172:175], v38, s[24:27], s56 offen offset:2048 sc1
  s_waitcnt vmcnt(0)
  v_lshl_add_u64 v[168:169], v[168:169], 0, v[28:29]
  v_lshl_add_u64 v[172:173], v[172:173], 0, v[28:29]
  v_or3_b32 v41, v168, v169, v172
  v_bitop3_b32 v41, v41, v173, s81 bitop3:0xa8
  v_cmp_ne_u32 vcc, 0, v41
  s_cbranch_vccz L_sl18_b
  s_add_u32 s43, s43, 1
  s_cmp_lt_u32 s43, 30000
  s_cbranch_scc1 L_sl18
  s_branch L_sl18_b
L_sl19:
  s_xor_b32 s56, s61, 8192
  buffer_load_dwordx4 v[176:179], v38, s[24:27], s56 offen offset:0 sc1
  buffer_load_dwordx4 v[180:183], v38, s[24:27], s56 offen offset:2048 sc1
  s_waitcnt vmcnt(0)
  v_lshl_add_u64 v[176:177], v[176:177], 0, v[28:29]
  v_lshl_add_u64 v[180:181], v[180:181], 0, v[28:29]
  v_or3_b32 v41, v176, v177, v180
  v_bitop3_b32 v41, v41, v181, s81 bitop3:0xa8
  v_cmp_ne_u32 vcc, 0, v41
  s_cbranch_vccz L_sl19_b
  s_add_u32 s43, s43, 1
  s_cmp_lt_u32 s43, 30000
  s_cbranch_scc1 L_sl19
  s_branch L_sl19_b
L_sl20:
  s_xor_b32 s56, s61, 12288
  buffer_load_dwordx4 v[184:187], v38, s[24:27], s56 offen offset:0 sc1
  buffer_load_dwordx4 v[188:191], v38, s[24:27], s56 offen offset:2048 sc1
  s_waitcnt vmcnt(0)
  v_lshl_add_u64 v[184:185], v[184:185], 0, v[28:29]
  v_lshl_add_u64 v[188:189], v[188:189], 0, v[28:29]
  v_or3_b32 v41, v184, v185, v188
  v_bitop3_b32 v41, v41, v189, s81 bitop3:0xa8
  v_cmp_ne_u32 vcc, 0, v41
  s_cbranch_vccz L_sl20_b
  s_add_u32 s43, s43, 1
  s_cmp_lt_u32 s43, 30000
  s_cbranch_scc1 L_sl20
  s_branch L_sl20_b
L_sl21:
  s_xor_b32 s56, s61, 16384
  buffer_load_dwordx4 v[192:195], v38, s[24:27], s56 offen offset:0 sc1
  buffer_load_dwordx4 v[196:199], v38, s[24:27], s56 offen offset:2048 sc1
  s_waitcnt vmcnt(0)
  v_lshl_add_u64 v[192:193], v[192:193], 0, v[28:29]
  v_lshl_add_u64 v[196:197], v[196:197], 0, v[28:29]
  v_or3_b32 v41, v192, v193, v196
  v_bitop3_b32 v41, v41, v197, s81 bitop3:0xa8
  v_cmp_ne_u32 vcc, 0, v41
  s_cbranch_vccz L_sl21_b
  s_add_u32 s43, s43, 1
  s_cmp_lt_u32 s43, 30000
  s_cbranch_scc1 L_sl21
  s_branch L_sl21_b
L_sl22:
  s_xor_b32 s56, s61, 20480
  buffer_load_dwordx4 v[200:203], v38, s[24:27], s56 offen offset:0 sc1
  buffer_load_dwordx4 v[204:207], v38, s[24:27], s56 offen offset:2048 sc1
  s_waitcnt vmcnt(0)
  v_lshl_add_u64 v[200:201], v[200:201], 0, v[28:29]
  v_lshl_add_u64 v[204:205], v[204:205], 0, v[28:29]
  v_or3_b32 v41, v200, v201, v204
  v_bitop3_b32 v41, v41, v205, s81 bitop3:0xa8
  v_cmp_ne_u32 vcc, 0, v41
  s_cbranch_vccz L_sl22_b
  s_add_u32 s43, s43, 1
  s_cmp_lt_u32 s43, 30000
  s_cbranch_scc1 L_sl22
  s_branch L_sl22_b
L_sl23:
  s_xor_b32 s56, s61, 24576
  buffer_load_dwordx4 v[208:211], v38, s[24:27], s56 offen offset:0 sc1
  buffer_load_dwordx4 v[212:215], v38, s[24:27], s56 offen offset:2048 sc1
  s_waitcnt vmcnt(0)
  v_lshl_add_u64 v[208:209], v[208:209], 0, v[28:29]
  v_lshl_add_u64 v[212:213], v[212:213], 0, v[28:29]
  v_or3_b32 v41, v208, v209, v212
  v_bitop3_b32 v41, v41, v213, s81 bitop3:0xa8
  v_cmp_ne_u32 vcc, 0, v41
  s_cbranch_vccz L_sl23_b
  s_add_u32 s43, s43, 1
  s_cmp_lt_u32 s43, 30000
  s_cbranch_scc1 L_sl23
  s_branch L_sl23_b
L_sl24:
  s_xor_b32 s56, s61, 28672
  buffer_load_dwordx4 v[216:219], v38, s[24:27], s56 offen offset:0 sc1
  buffer_load_dwordx4 v[220:223], v38, s[24:27], s56 offen offset:2048 sc1
  s_waitcnt vmcnt(0)
  v_lshl_add_u64 v[216:217], v[216:217], 0, v[28:29]
  v_lshl_add_u64 v[220:221], v[220:221], 0, v[28:29]
  v_or3_b32 v41, v216, v217, v220
  v_bitop3_b32 v41, v41, v221, s81 bitop3:0xa8
  v_cmp_ne_u32 vcc, 0, v41
  s_cbranch_vccz L_sl24_b
  s_add_u32 s43, s43, 1
  s_cmp_lt_u32 s43, 30000
  s_cbranch_scc1 L_sl24
  s_branch L_sl24_b
L_sl25:
  s_xor_b32 s56, s61, 32768
  buffer_load_dwordx4 v[160:163], v38, s[24:27], s56 offen offset:0 sc1
  buffer_load_dwordx4 v[164:167], v38, s[24:27], s56 offen offset:2048 sc1
  s_waitcnt vmcnt(0)
  v_lshl_add_u64 v[160:161], v[160:161], 0, v[28:29]
  v_lshl_add_u64 v[164:165], v[164:165], 0, v[28:29]
  v_or3_b32 v41, v160, v161, v164
  v_bitop3_b32 v41, v41, v165, s81 bitop3:0xa8
  v_cmp_ne_u32 vcc, 0, v41
  s_cbranch_vccz L_sl25_b
  s_add_u32 s43, s43, 1
  s_cmp_lt_u32 s43, 30000
  s_cbranch_scc1 L_sl25
  s_branch L_sl25_b
L_sl26:
  s_xor_b32 s56, s61, 36864
  buffer_load_dwordx4 v[168:171], v38, s[24:27], s56 offen offset:0 sc1
  buffer_load_dwordx4 v[172:175], v38, s[24:27], s56 offen offset:2048 sc1
  s_waitcnt vmcnt(0)
  v_lshl_add_u64 v[168:169], v[168:169], 0, v[28:29]
  v_lshl_add_u64 v[172:173], v[172:173], 0, v[28:29]
  v_or3_b32 v41, v168, v169, v172
  v_bitop3_b32 v41, v41, v173, s81 bitop3:0xa8
  v_cmp_ne_u32 vcc, 0, v41
  s_cbranch_vccz L_sl26_b
  s_add_u32 s43, s43, 1
  s_cmp_lt_u32 s43, 30000
  s_cbranch_scc1 L_sl26
  s_branch L_sl26_b
L_sl27:
  s_xor_b32 s56, s61, 40960
  buffer_load_dwordx4 v[176:179], v38, s[24:27], s56 offen offset:0 sc1
  buffer_load_dwordx4 v[180:183], v38, s[24:27], s56 offen offset:2048 sc1
  s_waitcnt vmcnt(0)
  v_lshl_add_u64 v[176:177], v[176:177], 0, v[28:29]
  v_lshl_add_u64 v[180:181], v[180:181], 0, v[28:29]
  v_or3_b32 v41, v176, v177, v180
  v_bitop3_b32 v41, v41, v181, s81 bitop3:0xa8
  v_cmp_ne_u32 vcc, 0, v41
  s_cbranch_vccz L_sl27_b
  s_add_u32 s43, s43, 1
  s_cmp_lt_u32 s43, 30000
  s_cbranch_scc1 L_sl27
  s_branch L_sl27_b
L_sl28:
  s_xor_b32 s56, s61, 45056
  buffer_load_dwordx4 v[184:187], v38, s[24:27], s56 offen offset:0 sc1
  buffer_load_dwordx4 v[188:191], v38, s[24:27], s56 offen offset:2048 sc1
  s_waitcnt vmcnt(0)
  v_lshl_add_u64 v[184:185], v[184:185], 0, v[28:29]
  v_lshl_add_u64 v[188:189], v[188:189], 0, v[28:29]
  v_or3_b32 v41, v184, v185, v188
  v_bitop3_b32 v41, v41, v189, s81 bitop3:0xa8
  v_cmp_ne_u32 vcc, 0, v41
  s_cbranch_vccz L_sl28_b
  s_add_u32 s43, s43, 1
  s_cmp_lt_u32 s43, 30000
  s_cbranch_scc1 L_sl28
  s_branch L_sl28_b
L_sl29:
  s_xor_b32 s56, s61, 0
  buffer_load_dwordx4 v[192:195], v35, s[24:27], s56 offen offset:0 sc1
  buffer_load_dwordx4 v[196:199], v35, s[24:27], s56 offen offset:2048 sc1
  s_waitcnt vmcnt(0)
  v_lshl_add_u64 v[192:193], v[192:193], 0, v[28:29]
  v_lshl_add_u64 v[196:197], v[196:197], 0, v[28:29]
  v_or3_b32 v41, v192, v193, v196
  v_bitop3_b32 v41, v41, v197, s81 bitop3:0xa8
  v_cmp_ne_u32 vcc, 0, v41
  s_cbranch_vccz L_sl29_b
  s_add_u32 s43, s43, 1
  s_cmp_lt_u32 s43, 30000
  s_cbranch_scc1 L_sl29
  s_branch L_sl29_b
L_sl30:
  s_xor_b32 s56, s61, 49152
  buffer_load_dwordx4 v[200:203], v38, s[24:27], s56 offen offset:0 sc1
  buffer_load_dwordx4 v[204:207], v38, s[24:27], s56 offen offset:2048 sc1
  s_waitcnt vmcnt(0)
  v_lshl_add_u64 v[200:201], v[200:201], 0, v[28:29]
  v_lshl_add_u64 v[204:205], v[204:205], 0, v[28:29]
  v_or3_b32 v41, v200, v201, v204
  v_bitop3_b32 v41, v41, v205, s81 bitop3:0xa8
  v_cmp_ne_u32 vcc, 0, v41
  s_cbranch_vccz L_sl30_b
  s_add_u32 s43, s43, 1
  s_cmp_lt_u32 s43, 30000
  s_cbranch_scc1 L_sl30
  s_branch L_sl30_b
L_sl31:
  s_xor_b32 s56, s61, 4096
  buffer_load_dwordx4 v[208:211], v35, s[24:27], s56 offen offset:0 sc1
  buffer_load_dwordx4 v[212:215], v35, s[24:27], s56 offen offset:2048 sc1
  s_waitcnt vmcnt(0)
  v_lshl_add_u64 v[208:209], v[208:209], 0, v[28:29]
  v_lshl_add_u64 v[212:213], v[212:213], 0, v[28:29]
  v_or3_b32 v41, v208, v209, v212
  v_bitop3_b32 v41, v41, v213, s81 bitop3:0xa8
  v_cmp_ne_u32 vcc, 0, v41
  s_cbranch_vccz L_sl31_b
  s_add_u32 s43, s43, 1
  s_cmp_lt_u32 s43, 30000
  s_cbranch_scc1 L_sl31
  s_branch L_sl31_b
L_sl32:
  s_xor_b32 s56, s61, 53248
  buffer_load_dwordx4 v[216:219], v38, s[24:27], s56 offen offset:0 sc1
  buffer_load_dwordx4 v[220:223], v38, s[24:27], s56 offen offset:2048 sc1
  s_waitcnt vmcnt(0)
  v_lshl_add_u64 v[216:217], v[216:217], 0, v[28:29]
  v_lshl_add_u64 v[220:221], v[220:221], 0, v[28:29]
  v_or3_b32 v41, v216, v217, v220
  v_bitop3_b32 v41, v41, v221, s81 bitop3:0xa8
  v_cmp_ne_u32 vcc, 0, v41
  s_cbranch_vccz L_sl32_b
  s_add_u32 s43, s43, 1
  s_cmp_lt_u32 s43, 30000
  s_cbranch_scc1 L_sl32
  s_branch L_sl32_b
L_sl33:
  s_xor_b32 s56, s61, 8192
  buffer_load_dwordx4 v[160:163], v35, s[24:27], s56 offen offset:0 sc1
  buffer_load_dwordx4 v[164:167], v35, s[24:27], s56 offen offset:2048 sc1
  s_waitcnt vmcnt(0)
  v_lshl_add_u64 v[160:161], v[160:161], 0, v[28:29]
  v_lshl_add_u64 v[164:165], v[164:165], 0, v[28:29]
  v_or3_b32 v41, v160, v161, v164
  v_bitop3_b32 v41, v41, v165, s81 bitop3:0xa8
  v_cmp_ne_u32 vcc, 0, v41
  s_cbranch_vccz L_sl33_b
  s_add_u32 s43, s43, 1
  s_cmp_lt_u32 s43, 30000
  s_cbranch_scc1 L_sl33
  s_branch L_sl33_b
L_sl34:
  s_xor_b32 s56, s61, 57344
  buffer_load_dwordx4 v[168:171], v38, s[24:27], s56 offen offset:0 sc1
  buffer_load_dwordx4 v[172:175], v38, s[24:27], s56 offen offset:2048 sc1
  s_waitcnt vmcnt(0)
  v_lshl_add_u64 v[168:169], v[168:169], 0, v[28:29]
  v_lshl_add_u64 v[172:173], v[172:173], 0, v[28:29]
  v_or3_b32 v41, v168, v169, v172
  v_bitop3_b32 v41, v41, v173, s81 bitop3:0xa8
  v_cmp_ne_u32 vcc, 0, v41
  s_cbranch_vccz L_sl34_b
  s_add_u32 s43, s43, 1
  s_cmp_lt_u32 s43, 30000
  s_cbranch_scc1 L_sl34
  s_branch L_sl34_b
L_sl35:
  s_xor_b32 s56, s61, 12288
  buffer_load_dwordx4 v[176:179], v35, s[24:27], s56 offen offset:0 sc1
  buffer_load_dwordx4 v[180:183], v35, s[24:27], s56 offen offset:2048 sc1
  s_waitcnt vmcnt(0)
  v_lshl_add_u64 v[176:177], v[176:177], 0, v[28:29]
  v_lshl_add_u64 v[180:181], v[180:181], 0, v[28:29]
  v_or3_b32 v41, v176, v177, v180
  v_bitop3_b32 v41, v41, v181, s81 bitop3:0xa8
  v_cmp_ne_u32 vcc, 0, v41
  s_cbranch_vccz L_sl35_b
  s_add_u32 s43, s43, 1
  s_cmp_lt_u32 s43, 30000
  s_cbranch_scc1 L_sl35
  s_branch L_sl35_b
L_sl36:
  s_xor_b32 s56, s61, 61440
  buffer_load_dwordx4 v[184:187], v38, s[24:27], s56 offen offset:0 sc1
  buffer_load_dwordx4 v[188:191], v38, s[24:27], s56 offen offset:2048 sc1
  s_waitcnt vmcnt(0)
  v_lshl_add_u64 v[184:185], v[184:185], 0, v[28:29]
  v_lshl_add_u64 v[188:189], v[188:189], 0, v[28:29]
  v_or3_b32 v41, v184, v185, v188
  v_bitop3_b32 v41, v41, v189, s81 bitop3:0xa8
  v_cmp_ne_u32 vcc, 0, v41
  s_cbranch_vccz L_sl36_b
  s_add_u32 s43, s43, 1
  s_cmp_lt_u32 s43, 30000
  s_cbranch_scc1 L_sl36
  s_branch L_sl36_b
L_sl37:
  s_xor_b32 s56, s61, 16384
  buffer_load_dwordx4 v[192:195], v35, s[24:27], s56 offen offset:0 sc1
  buffer_load_dwordx4 v[196:199], v35, s[24:27], s56 offen offset:2048 sc1
  s_waitcnt vmcnt(0)
  v_lshl_add_u64 v[192:193], v[192:193], 0, v[28:29]
  v_lshl_add_u64 v[196:197], v[196:197], 0, v[28:29]
  v_or3_b32 v41, v192, v193, v196
  v_bitop3_b32 v41, v41, v197, s81 bitop3:0xa8
  v_cmp_ne_u32 vcc, 0, v41
  s_cbranch_vccz L_sl37_b
  s_add_u32 s43, s43, 1
  s_cmp_lt_u32 s43, 30000
  s_cbranch_scc1 L_sl37
  s_branch L_sl37_b
L_sl38:
  s_xor_b32 s56, s61, 20480
  buffer_load_dwordx4 v[200:203], v35, s[24:27], s56 offen offset:0 sc1
  buffer_load_dwordx4 v[204:207], v35, s[24:27], s56 offen offset:2048 sc1
  s_waitcnt vmcnt(0)
  v_lshl_add_u64 v[200:201], v[200:201], 0, v[28:29]
  v_lshl_add_u64 v[204:205], v[204:205], 0, v[28:29]
  v_or3_b32 v41, v200, v201, v204
  v_bitop3_b32 v41, v41, v205, s81 bitop3:0xa8
  v_cmp_ne_u32 vcc, 0, v41
  s_cbranch_vccz L_sl38_b
  s_add_u32 s43, s43, 1
  s_cmp_lt_u32 s43, 30000
  s_cbranch_scc1 L_sl38
  s_branch L_sl38_b
L_sl39:
  s_xor_b32 s56, s61, 24576
  buffer_load_dwordx4 v[208:211], v35, s[24:27], s56 offen offset:0 sc1
  buffer_load_dwordx4 v[212:215], v35, s[24:27], s56 offen offset:2048 sc1
  s_waitcnt vmcnt(0)
  v_lshl_add_u64 v[208:209], v[208:209], 0, v[28:29]
  v_lshl_add_u64 v[212:213], v[212:213], 0, v[28:29]
  v_or3_b32 v41, v208, v209, v212
  v_bitop3_b32 v41, v41, v213, s81 bitop3:0xa8
  v_cmp_ne_u32 vcc, 0, v41
  s_cbranch_vccz L_sl39_b
  s_add_u32 s43, s43, 1
  s_cmp_lt_u32 s43, 30000
  s_cbranch_scc1 L_sl39
  s_branch L_sl39_b
L_sl40:
  s_xor_b32 s56, s61, 28672
  buffer_load_dwordx4 v[216:219], v35, s[24:27], s56 offen offset:0 sc1
  buffer_load_dwordx4 v[220:223], v35, s[24:27], s56 offen offset:2048 sc1
  s_waitcnt vmcnt(0)
  v_lshl_add_u64 v[216:217], v[216:217], 0, v[28:29]
  v_lshl_add_u64 v[220:221], v[220:221], 0, v[28:29]
  v_or3_b32 v41, v216, v217, v220
  v_bitop3_b32 v41, v41, v221, s81 bitop3:0xa8
  v_cmp_ne_u32 vcc, 0, v41
  s_cbranch_vccz L_sl40_b
  s_add_u32 s43, s43, 1
  s_cmp_lt_u32 s43, 30000
  s_cbranch_scc1 L_sl40
  s_branch L_sl40_b
L_sl41:
  s_xor_b32 s56, s61, 32768
  buffer_load_dwordx4 v[160:163], v35, s[24:27], s56 offen offset:0 sc1
  buffer_load_dwordx4 v[164:167], v35, s[24:27], s56 offen offset:2048 sc1
  s_waitcnt vmcnt(0)
  v_lshl_add_u64 v[160:161], v[160:161], 0, v[28:29]
  v_lshl_add_u64 v[164:165], v[164:165], 0, v[28:29]
  v_or3_b32 v41, v160, v161, v164
  v_bitop3_b32 v41, v41, v165, s81 bitop3:0xa8
  v_cmp_ne_u32 vcc, 0, v41
  s_cbranch_vccz L_sl41_b
  s_add_u32 s43, s43, 1
  s_cmp_lt_u32 s43, 30000
  s_cbranch_scc1 L_sl41
  s_branch L_sl41_b
L_ss42:
  buffer_store_dwordx4 v[112:115], v12, s[24:27], 0 offen offset:0 sc1
  s_branch L_ss42_e
L_sl43:
  s_xor_b32 s56, s61, 36864
  buffer_load_dwordx4 v[168:171], v35, s[24:27], s56 offen offset:0 sc1
  buffer_load_dwordx4 v[172:175], v35, s[24:27], s56 offen offset:2048 sc1
  s_waitcnt vmcnt(0)
  v_lshl_add_u64 v[168:169], v[168:169], 0, v[28:29]
  v_lshl_add_u64 v[172:173], v[172:173], 0, v[28:29]
  v_or3_b32 v41, v168, v169, v172
  v_bitop3_b32 v41, v41, v173, s81 bitop3:0xa8
  v_cmp_ne_u32 vcc, 0, v41
  s_cbranch_vccz L_sl43_b
  s_add_u32 s43, s43, 1
  s_cmp_lt_u32 s43, 30000
  s_cbranch_scc1 L_sl43
  s_branch L_sl43_b
L_ss44:
  buffer_store_dwordx4 v[116:119], v12, s[24:27], 0 offen offset:1024 sc1
  s_branch L_ss44_e
L_sl45:
  s_xor_b32 s56, s61, 40960
  buffer_load_dwordx4 v[176:179], v35, s[24:27], s56 offen offset:0 sc1
  buffer_load_dwordx4 v[180:183], v35, s[24:27], s56 offen offset:2048 sc1
  s_waitcnt vmcnt(0)
  v_lshl_add_u64 v[176:177], v[176:177], 0, v[28:29]
  v_lshl_add_u64 v[180:181], v[180:181], 0, v[28:29]
  v_or3_b32 v41, v176, v177, v180
  v_bitop3_b32 v41, v41, v181, s81 bitop3:0xa8
  v_cmp_ne_u32 vcc, 0, v41
  s_cbranch_vccz L_sl45_b
  s_add_u32 s43, s43, 1
  s_cmp_lt_u32 s43, 30000
  s_cbranch_scc1 L_sl45
  s_branch L_sl45_b
L_sl46:
  s_xor_b32 s56, s61, 45056
  buffer_load_dwordx4 v[184:187], v35, s[24:27], s56 offen offset:0 sc1
  buffer_load_dwordx4 v[188:191], v35, s[24:27], s56 offen offset:2048 sc1
  s_waitcnt vmcnt(0)
  v_lshl_add_u64 v[184:185], v[184:185], 0, v[28:29]
  v_lshl_add_u64 v[188:189], v[188:189], 0, v[28:29]
  v_or3_b32 v41, v184, v185, v188
  v_bitop3_b32 v41, v41, v189, s81 bitop3:0xa8
  v_cmp_ne_u32 vcc, 0, v41
  s_cbranch_vccz L_sl46_b
  s_add_u32 s43, s43, 1
  s_cmp_lt_u32 s43, 30000
  s_cbranch_scc1 L_sl46
  s_branch L_sl46_b
L_sl47:
  s_xor_b32 s56, s61, 49152
  buffer_load_dwordx4 v[192:195], v35, s[24:27], s56 offen offset:0 sc1
  buffer_load_dwordx4 v[196:199], v35, s[24:27], s56 offen offset:2048 sc1
  s_waitcnt vmcnt(0)
  v_lshl_add_u64 v[192:193], v[192:193], 0, v[28:29]
  v_lshl_add_u64 v[196:197], v[196:197], 0, v[28:29]
  v_or3_b32 v41, v192, v193, v196
  v_bitop3_b32 v41, v41, v197, s81 bitop3:0xa8
  v_cmp_ne_u32 vcc, 0, v41
  s_cbranch_vccz L_sl47_b
  s_add_u32 s43, s43, 1
  s_cmp_lt_u32 s43, 30000
  s_cbranch_scc1 L_sl47
  s_branch L_sl47_b
L_sl48:
  s_xor_b32 s56, s61, 53248
  buffer_load_dwordx4 v[200:203], v35, s[24:27], s56 offen offset:0 sc1
  buffer_load_dwordx4 v[204:207], v35, s[24:27], s56 offen offset:2048 sc1
  s_waitcnt vmcnt(0)
  v_lshl_add_u64 v[200:201], v[200:201], 0, v[28:29]
  v_lshl_add_u64 v[204:205], v[204:205], 0, v[28:29]
  v_or3_b32 v41, v200, v201, v204
  v_bitop3_b32 v41, v41, v205, s81 bitop3:0xa8
  v_cmp_ne_u32 vcc, 0, v41
  s_cbranch_vccz L_sl48_b
  s_add_u32 s43, s43, 1
  s_cmp_lt_u32 s43, 30000
  s_cbranch_scc1 L_sl48
  s_branch L_sl48_b
L_sl49:
  s_xor_b32 s56, s61, 57344
  buffer_load_dwordx4 v[208:211], v35, s[24:27], s56 offen offset:0 sc1
  buffer_load_dwordx4 v[212:215], v35, s[24:27], s56 offen offset:2048 sc1
  s_waitcnt vmcnt(0)
  v_lshl_add_u64 v[208:209], v[208:209], 0, v[28:29]
  v_lshl_add_u64 v[212:213], v[212:213], 0, v[28:29]
  v_or3_b32 v41, v208, v209, v212
  v_bitop3_b32 v41, v41, v213, s81 bitop3:0xa8
  v_cmp_ne_u32 vcc, 0, v41
  s_cbranch_vccz L_sl49_b
  s_add_u32 s43, s43, 1
  s_cmp_lt_u32 s43, 30000
  s_cbranch_scc1 L_sl49
  s_branch L_sl49_b
L_sl50:
  s_xor_b32 s56, s61, 61440
  buffer_load_dwordx4 v[216:219], v35, s[24:27], s56 offen offset:0 sc1
  buffer_load_dwordx4 v[220:223], v35, s[24:27], s56 offen offset:2048 sc1
  s_waitcnt vmcnt(0)
  v_lshl_add_u64 v[216:217], v[216:217], 0, v[28:29]
  v_lshl_add_u64 v[220:221], v[220:221], 0, v[28:29]
  v_or3_b32 v41, v216, v217, v220
  v_bitop3_b32 v41, v41, v221, s81 bitop3:0xa8
  v_cmp_ne_u32 vcc, 0, v41
  s_cbranch_vccz L_sl50_b
  s_add_u32 s43, s43, 1
  s_cmp_lt_u32 s43, 30000
  s_cbranch_scc1 L_sl50
  s_branch L_sl50_b
L_sl53:
  s_xor_b32 s56, s49, 0
  buffer_load_dwordx4 v[176:179], v30, s[24:27], s56 offen offset:0 sc1
  buffer_load_dwordx4 v[180:183], v30, s[24:27], s56 offen offset:2048 sc1
  s_waitcnt vmcnt(0)
  v_lshl_add_u64 v[176:177], v[176:177], 0, v[28:29]
  v_lshl_add_u64 v[180:181], v[180:181], 0, v[28:29]
  v_or3_b32 v15, v176, v177, v180
  v_bitop3_b32 v15, v15, v181, s81 bitop3:0xa8
  v_cmp_ne_u32 vcc, 0, v15
  s_cbranch_vccz L_sl53_b
  s_add_u32 s43, s43, 1
  s_cmp_lt_u32 s43, 30000
  s_cbranch_scc1 L_sl53
  s_branch L_sl53_b
L_sl54:
  s_xor_b32 s56, s49, 4096
  buffer_load_dwordx4 v[184:187], v30, s[24:27], s56 offen offset:0 sc1
  buffer_load_dwordx4 v[188:191], v30, s[24:27], s56 offen offset:2048 sc1
  s_waitcnt vmcnt(0)
  v_lshl_add_u64 v[184:185], v[184:185], 0, v[28:29]
  v_lshl_add_u64 v[188:189], v[188:189], 0, v[28:29]
  v_or3_b32 v15, v184, v185, v188
  v_bitop3_b32 v15, v15, v189, s81 bitop3:0xa8
  v_cmp_ne_u32 vcc, 0, v15
  s_cbranch_vccz L_sl54_b
  s_add_u32 s43, s43, 1
  s_cmp_lt_u32 s43, 30000
  s_cbranch_scc1 L_sl54
  s_branch L_sl54_b
L_sl55:
  s_xor_b32 s56, s49, 8192
  buffer_load_dwordx4 v[192:195], v30, s[24:27], s56 offen offset:0 sc1
  buffer_load_dwordx4 v[196:199], v30, s[24:27], s56 offen offset:2048 sc1
  s_waitcnt vmcnt(0)
  v_lshl_add_u64 v[192:193], v[192:193], 0, v[28:29]
  v_lshl_add_u64 v[196:197], v[196:197], 0, v[28:29]
  v_or3_b32 v15, v192, v193, v196
  v_bitop3_b32 v15, v15, v197, s81 bitop3:0xa8
  v_cmp_ne_u32 vcc, 0, v15
  s_cbranch_vccz L_sl55_b
  s_add_u32 s43, s43, 1
  s_cmp_lt_u32 s43, 30000
  s_cbranch_scc1 L_sl55
  s_branch L_sl55_b
L_sl56:
  s_xor_b32 s56, s49, 12288
  buffer_load_dwordx4 v[200:203], v30, s[24:27], s56 offen offset:0 sc1
  buffer_load_dwordx4 v[204:207], v30, s[24:27], s56 offen offset:2048 sc1
  s_waitcnt vmcnt(0)
  v_lshl_add_u64 v[200:201], v[200:201], 0, v[28:29]
  v_lshl_add_u64 v[204:205], v[204:205], 0, v[28:29]
  v_or3_b32 v15, v200, v201, v204
  v_bitop3_b32 v15, v15, v205, s81 bitop3:0xa8
  v_cmp_ne_u32 vcc, 0, v15
  s_cbranch_vccz L_sl56_b
  s_add_u32 s43, s43, 1
  s_cmp_lt_u32 s43, 30000
  s_cbranch_scc1 L_sl56
  s_branch L_sl56_b
L_sl57:
  s_xor_b32 s56, s49, 16384
  buffer_load_dwordx4 v[208:211], v30, s[24:27], s56 offen offset:0 sc1
  buffer_load_dwordx4 v[212:215], v30, s[24:27], s56 offen offset:2048 sc1
  s_waitcnt vmcnt(0)
  v_lshl_add_u64 v[208:209], v[208:209], 0, v[28:29]
  v_lshl_add_u64 v[212:213], v[212:213], 0, v[28:29]
  v_or3_b32 v15, v208, v209, v212
  v_bitop3_b32 v15, v15, v213, s81 bitop3:0xa8
  v_cmp_ne_u32 vcc, 0, v15
  s_cbranch_vccz L_sl57_b
  s_add_u32 s43, s43, 1
  s_cmp_lt_u32 s43, 30000
  s_cbranch_scc1 L_sl57
  s_branch L_sl57_b
L_sl58:
  s_xor_b32 s56, s49, 20480
  buffer_load_dwordx4 v[216:219], v30, s[24:27], s56 offen offset:0 sc1
  buffer_load_dwordx4 v[220:223], v30, s[24:27], s56 offen offset:2048 sc1
  s_waitcnt vmcnt(0)
  v_lshl_add_u64 v[216:217], v[216:217], 0, v[28:29]
  v_lshl_add_u64 v[220:221], v[220:221], 0, v[28:29]
  v_or3_b32 v15, v216, v217, v220
  v_bitop3_b32 v15, v15, v221, s81 bitop3:0xa8
  v_cmp_ne_u32 vcc, 0, v15
  s_cbranch_vccz L_sl58_b
  s_add_u32 s43, s43, 1
  s_cmp_lt_u32 s43, 30000
  s_cbranch_scc1 L_sl58
  s_branch L_sl58_b
L_sl59:
  s_xor_b32 s56, s49, 24576
  buffer_load_dwordx4 v[224:227], v30, s[24:27], s56 offen offset:0 sc1
  buffer_load_dwordx4 v[228:231], v30, s[24:27], s56 offen offset:2048 sc1
  s_waitcnt vmcnt(0)
  v_lshl_add_u64 v[224:225], v[224:225], 0, v[28:29]
  v_lshl_add_u64 v[228:229], v[228:229], 0, v[28:29]
  v_or3_b32 v15, v224, v225, v228
  v_bitop3_b32 v15, v15, v229, s81 bitop3:0xa8
  v_cmp_ne_u32 vcc, 0, v15
  s_cbranch_vccz L_sl59_b
  s_add_u32 s43, s43, 1
  s_cmp_lt_u32 s43, 30000
  s_cbranch_scc1 L_sl59
  s_branch L_sl59_b
L_sl60:
  s_xor_b32 s56, s49, 28672
  buffer_load_dwordx4 v[232:235], v30, s[24:27], s56 offen offset:0 sc1
  buffer_load_dwordx4 v[236:239], v30, s[24:27], s56 offen offset:2048 sc1
  s_waitcnt vmcnt(0)
  v_lshl_add_u64 v[232:233], v[232:233], 0, v[28:29]
  v_lshl_add_u64 v[236:237], v[236:237], 0, v[28:29]
  v_or3_b32 v15, v232, v233, v236
  v_bitop3_b32 v15, v15, v237, s81 bitop3:0xa8
  v_cmp_ne_u32 vcc, 0, v15
  s_cbranch_vccz L_sl60_b
  s_add_u32 s43, s43, 1
  s_cmp_lt_u32 s43, 30000
  s_cbranch_scc1 L_sl60
  s_branch L_sl60_b
L_sl61:
  s_xor_b32 s56, s49, 32768
  buffer_load_dwordx4 v[176:179], v30, s[24:27], s56 offen offset:0 sc1
  buffer_load_dwordx4 v[180:183], v30, s[24:27], s56 offen offset:2048 sc1
  s_waitcnt vmcnt(0)
  v_lshl_add_u64 v[176:177], v[176:177], 0, v[28:29]
  v_lshl_add_u64 v[180:181], v[180:181], 0, v[28:29]
  v_or3_b32 v15, v176, v177, v180
  v_bitop3_b32 v15, v15, v181, s81 bitop3:0xa8
  v_cmp_ne_u32 vcc, 0, v15
  s_cbranch_vccz L_sl61_b
  s_add_u32 s43, s43, 1
  s_cmp_lt_u32 s43, 30000
  s_cbranch_scc1 L_sl61
  s_branch L_sl61_b
L_sl62:
  s_xor_b32 s56, s49, 36864
  buffer_load_dwordx4 v[184:187], v30, s[24:27], s56 offen offset:0 sc1
  buffer_load_dwordx4 v[188:191], v30, s[24:27], s56 offen offset:2048 sc1
  s_waitcnt vmcnt(0)
  v_lshl_add_u64 v[184:185], v[184:185], 0, v[28:29]
  v_lshl_add_u64 v[188:189], v[188:189], 0, v[28:29]
  v_or3_b32 v15, v184, v185, v188
  v_bitop3_b32 v15, v15, v189, s81 bitop3:0xa8
  v_cmp_ne_u32 vcc, 0, v15
  s_cbranch_vccz L_sl62_b
  s_add_u32 s43, s43, 1
  s_cmp_lt_u32 s43, 30000
  s_cbranch_scc1 L_sl62
  s_branch L_sl62_b
L_sl63:
  s_xor_b32 s56, s49, 40960
  buffer_load_dwordx4 v[192:195], v30, s[24:27], s56 offen offset:0 sc1
  buffer_load_dwordx4 v[196:199], v30, s[24:27], s56 offen offset:2048 sc1
  s_waitcnt vmcnt(0)
  v_lshl_add_u64 v[192:193], v[192:193], 0, v[28:29]
  v_lshl_add_u64 v[196:197], v[196:197], 0, v[28:29]
  v_or3_b32 v15, v192, v193, v196
  v_bitop3_b32 v15, v15, v197, s81 bitop3:0xa8
  v_cmp_ne_u32 vcc, 0, v15
  s_cbranch_vccz L_sl63_b
  s_add_u32 s43, s43, 1
  s_cmp_lt_u32 s43, 30000
  s_cbranch_scc1 L_sl63
  s_branch L_sl63_b
L_sl64:
  s_xor_b32 s56, s49, 45056
  buffer_load_dwordx4 v[200:203], v30, s[24:27], s56 offen offset:0 sc1
  buffer_load_dwordx4 v[204:207], v30, s[24:27], s56 offen offset:2048 sc1
  s_waitcnt vmcnt(0)
  v_lshl_add_u64 v[200:201], v[200:201], 0, v[28:29]
  v_lshl_add_u64 v[204:205], v[204:205], 0, v[28:29]
  v_or3_b32 v15, v200, v201, v204
  v_bitop3_b32 v15, v15, v205, s81 bitop3:0xa8
  v_cmp_ne_u32 vcc, 0, v15
  s_cbranch_vccz L_sl64_b
  s_add_u32 s43, s43, 1
  s_cmp_lt_u32 s43, 30000
  s_cbranch_scc1 L_sl64
  s_branch L_sl64_b
L_sl65:
  s_xor_b32 s56, s49, 0
  buffer_load_dwordx4 v[208:211], v14, s[24:27], s56 offen offset:0 sc1
  buffer_load_dwordx4 v[212:215], v14, s[24:27], s56 offen offset:2048 sc1
  s_waitcnt vmcnt(0)
  v_lshl_add_u64 v[208:209], v[208:209], 0, v[28:29]
  v_lshl_add_u64 v[212:213], v[212:213], 0, v[28:29]
  v_or3_b32 v15, v208, v209, v212
  v_bitop3_b32 v15, v15, v213, s81 bitop3:0xa8
  v_cmp_ne_u32 vcc, 0, v15
  s_cbranch_vccz L_sl65_b
  s_add_u32 s43, s43, 1
  s_cmp_lt_u32 s43, 30000
  s_cbranch_scc1 L_sl65
  s_branch L_sl65_b
L_sl66:
  s_xor_b32 s56, s49, 49152
  buffer_load_dwordx4 v[216:219], v30, s[24:27], s56 offen offset:0 sc1
  buffer_load_dwordx4 v[220:223], v30, s[24:27], s56 offen offset:2048 sc1
  s_waitcnt vmcnt(0)
  v_lshl_add_u64 v[216:217], v[216:217], 0, v[28:29]
  v_lshl_add_u64 v[220:221], v[220:221], 0, v[28:29]
  v_or3_b32 v15, v216, v217, v220
  v_bitop3_b32 v15, v15, v221, s81 bitop3:0xa8
  v_cmp_ne_u32 vcc, 0, v15
  s_cbranch_vccz L_sl66_b
  s_add_u32 s43, s43, 1
  s_cmp_lt_u32 s43, 30000
  s_cbranch_scc1 L_sl66
  s_branch L_sl66_b
L_sl67:
  s_xor_b32 s56, s49, 4096
  buffer_load_dwordx4 v[224:227], v14, s[24:27], s56 offen offset:0 sc1
  buffer_load_dwordx4 v[228:231], v14, s[24:27], s56 offen offset:2048 sc1
  s_waitcnt vmcnt(0)
  v_lshl_add_u64 v[224:225], v[224:225], 0, v[28:29]
  v_lshl_add_u64 v[228:229], v[228:229], 0, v[28:29]
  v_or3_b32 v15, v224, v225, v228
  v_bitop3_b32 v15, v15, v229, s81 bitop3:0xa8
  v_cmp_ne_u32 vcc, 0, v15
  s_cbranch_vccz L_sl67_b
  s_add_u32 s43, s43, 1
  s_cmp_lt_u32 s43, 30000
  s_cbranch_scc1 L_sl67
  s_branch L_sl67_b
L_sl68:
  s_xor_b32 s56, s49, 53248
  buffer_load_dwordx4 v[232:235], v30, s[24:27], s56 offen offset:0 sc1
  buffer_load_dwordx4 v[236:239], v30, s[24:27], s56 offen offset:2048 sc1
  s_waitcnt vmcnt(0)
  v_lshl_add_u64 v[232:233], v[232:233], 0, v[28:29]
  v_lshl_add_u64 v[236:237], v[236:237], 0, v[28:29]
  v_or3_b32 v15, v232, v233, v236
  v_bitop3_b32 v15, v15, v237, s81 bitop3:0xa8
  v_cmp_ne_u32 vcc, 0, v15
  s_cbranch_vccz L_sl68_b
  s_add_u32 s43, s43, 1
  s_cmp_lt_u32 s43, 30000
  s_cbranch_scc1 L_sl68
  s_branch L_sl68_b
L_sl69:
  s_xor_b32 s56, s49, 8192
  buffer_load_dwordx4 v[176:179], v14, s[24:27], s56 offen offset:0 sc1
  buffer_load_dwordx4 v[180:183], v14, s[24:27], s56 offen offset:2048 sc1
  s_waitcnt vmcnt(0)
  v_lshl_add_u64 v[176:177], v[176:177], 0, v[28:29]
  v_lshl_add_u64 v[180:181], v[180:181], 0, v[28:29]
  v_or3_b32 v15, v176, v177, v180
  v_bitop3_b32 v15, v15, v181, s81 bitop3:0xa8
  v_cmp_ne_u32 vcc, 0, v15
  s_cbranch_vccz L_sl69_b
  s_add_u32 s43, s43, 1
  s_cmp_lt_u32 s43, 30000
  s_cbranch_scc1 L_sl69
  s_branch L_sl69_b
L_sl70:
  s_xor_b32 s56, s49, 12288
  buffer_load_dwordx4 v[184:187], v14, s[24:27], s56 offen offset:0 sc1
  buffer_load_dwordx4 v[188:191], v14, s[24:27], s56 offen offset:2048 sc1
  s_waitcnt vmcnt(0)
  v_lshl_add_u64 v[184:185], v[184:185], 0, v[28:29]
  v_lshl_add_u64 v[188:189], v[188:189], 0, v[28:29]
  v_or3_b32 v15, v184, v185, v188
  v_bitop3_b32 v15, v15, v189, s81 bitop3:0xa8
  v_cmp_ne_u32 vcc, 0, v15
  s_cbranch_vccz L_sl70_b
  s_add_u32 s43, s43, 1
  s_cmp_lt_u32 s43, 30000
  s_cbranch_scc1 L_sl70
  s_branch L_sl70_b
L_sl71:
  s_xor_b32 s56, s49, 16384
  buffer_load_dwordx4 v[192:195], v14, s[24:27], s56 offen offset:0 sc1
  buffer_load_dwordx4 v[196:199], v14, s[24:27], s56 offen offset:2048 sc1
  s_waitcnt vmcnt(0)
  v_lshl_add_u64 v[192:193], v[192:193], 0, v[28:29]
  v_lshl_add_u64 v[196:197], v[196:197], 0, v[28:29]
  v_or3_b32 v15, v192, v193, v196
  v_bitop3_b32 v15, v15, v197, s81 bitop3:0xa8
  v_cmp_ne_u32 vcc, 0, v15
  s_cbranch_vccz L_sl71_b
  s_add_u32 s43, s43, 1
  s_cmp_lt_u32 s43, 30000
  s_cbranch_scc1 L_sl71
  s_branch L_sl71_b
L_sl72:
  s_xor_b32 s56, s49, 20480
  buffer_load_dwordx4 v[200:203], v14, s[24:27], s56 offen offset:0 sc1
  buffer_load_dwordx4 v[204:207], v14, s[24:27], s56 offen offset:2048 sc1
  s_waitcnt vmcnt(0)
  v_lshl_add_u64 v[200:201], v[200:201], 0, v[28:29]
  v_lshl_add_u64 v[204:205], v[204:205], 0, v[28:29]
  v_or3_b32 v15, v200, v201, v204
  v_bitop3_b32 v15, v15, v205, s81 bitop3:0xa8
  v_cmp_ne_u32 vcc, 0, v15
  s_cbranch_vccz L_sl72_b
  s_add_u32 s43, s43, 1
  s_cmp_lt_u32 s43, 30000
  s_cbranch_scc1 L_sl72
  s_branch L_sl72_b
L_sl73:
  s_xor_b32 s56, s49, 24576
  buffer_load_dwordx4 v[208:211], v14, s[24:27], s56 offen offset:0 sc1
  buffer_load_dwordx4 v[212:215], v14, s[24:27], s56 offen offset:2048 sc1
  s_waitcnt vmcnt(0)
  v_lshl_add_u64 v[208:209], v[208:209], 0, v[28:29]
  v_lshl_add_u64 v[212:213], v[212:213], 0, v[28:29]
  v_or3_b32 v15, v208, v209, v212
  v_bitop3_b32 v15, v15, v213, s81 bitop3:0xa8
  v_cmp_ne_u32 vcc, 0, v15
  s_cbranch_vccz L_sl73_b
  s_add_u32 s43, s43, 1
  s_cmp_lt_u32 s43, 30000
  s_cbranch_scc1 L_sl73
  s_branch L_sl73_b
L_ss74:
  buffer_store_dwordx4 v[128:131], v13, s[24:27], 0 offen offset:0 sc1
  s_branch L_ss74_e
L_sl75:
  s_xor_b32 s56, s49, 28672
  buffer_load_dwordx4 v[216:219], v14, s[24:27], s56 offen offset:0 sc1
  buffer_load_dwordx4 v[220:223], v14, s[24:27], s56 offen offset:2048 sc1
  s_waitcnt vmcnt(0)
  v_lshl_add_u64 v[216:217], v[216:217], 0, v[28:29]
  v_lshl_add_u64 v[220:221], v[220:221], 0, v[28:29]
  v_or3_b32 v15, v216, v217, v220
  v_bitop3_b32 v15, v15, v221, s81 bitop3:0xa8
  v_cmp_ne_u32 vcc, 0, v15
  s_cbranch_vccz L_sl75_b
  s_add_u32 s43, s43, 1
  s_cmp_lt_u32 s43, 30000
  s_cbranch_scc1 L_sl75
  s_branch L_sl75_b
L_ss76:
  buffer_store_dwordx4 v[132:135], v13, s[24:27], 0 offen offset:1024 sc1
  s_branch L_ss76_e
L_sl77:
  s_xor_b32 s56, s49, 32768
  buffer_load_dwordx4 v[224:227], v14, s[24:27], s56 offen offset:0 sc1
  buffer_load_dwordx4 v[228:231], v14, s[24:27], s56 offen offset:2048 sc1
  s_waitcnt vmcnt(0)
  v_lshl_add_u64 v[224:225], v[224:225], 0, v[28:29]
  v_lshl_add_u64 v[228:229], v[228:229], 0, v[28:29]
  v_or3_b32 v15, v224, v225, v228
  v_bitop3_b32 v15, v15, v229, s81 bitop3:0xa8
  v_cmp_ne_u32 vcc, 0, v15
  s_cbranch_vccz L_sl77_b
  s_add_u32 s43, s43, 1
  s_cmp_lt_u32 s43, 30000
  s_cbranch_scc1 L_sl77
  s_branch L_sl77_b
L_sl78:
  s_xor_b32 s56, s49, 36864
  buffer_load_dwordx4 v[232:235], v14, s[24:27], s56 offen offset:0 sc1
  buffer_load_dwordx4 v[236:239], v14, s[24:27], s56 offen offset:2048 sc1
  s_waitcnt vmcnt(0)
  v_lshl_add_u64 v[232:233], v[232:233], 0, v[28:29]
  v_lshl_add_u64 v[236:237], v[236:237], 0, v[28:29]
  v_or3_b32 v15, v232, v233, v236
  v_bitop3_b32 v15, v15, v237, s81 bitop3:0xa8
  v_cmp_ne_u32 vcc, 0, v15
  s_cbranch_vccz L_sl78_b
  s_add_u32 s43, s43, 1
  s_cmp_lt_u32 s43, 30000
  s_cbranch_scc1 L_sl78
  s_branch L_sl78_b
L_sl79:
  s_xor_b32 s56, s49, 40960
  buffer_load_dwordx4 v[176:179], v14, s[24:27], s56 offen offset:0 sc1
  buffer_load_dwordx4 v[180:183], v14, s[24:27], s56 offen offset:2048 sc1
  s_waitcnt vmcnt(0)
  v_lshl_add_u64 v[176:177], v[176:177], 0, v[28:29]
  v_lshl_add_u64 v[180:181], v[180:181], 0, v[28:29]
  v_or3_b32 v15, v176, v177, v180
  v_bitop3_b32 v15, v15, v181, s81 bitop3:0xa8
  v_cmp_ne_u32 vcc, 0, v15
  s_cbranch_vccz L_sl79_b
  s_add_u32 s43, s43, 1
  s_cmp_lt_u32 s43, 30000
  s_cbranch_scc1 L_sl79
  s_branch L_sl79_b
L_sl80:
  s_xor_b32 s56, s49, 45056
  buffer_load_dwordx4 v[184:187], v14, s[24:27], s56 offen offset:0 sc1
  buffer_load_dwordx4 v[188:191], v14, s[24:27], s56 offen offset:2048 sc1
  s_waitcnt vmcnt(0)
  v_lshl_add_u64 v[184:185], v[184:185], 0, v[28:29]
  v_lshl_add_u64 v[188:189], v[188:189], 0, v[28:29]
  v_or3_b32 v15, v184, v185, v188
  v_bitop3_b32 v15, v15, v189, s81 bitop3:0xa8
  v_cmp_ne_u32 vcc, 0, v15
  s_cbranch_vccz L_sl80_b
  s_add_u32 s43, s43, 1
  s_cmp_lt_u32 s43, 30000
  s_cbranch_scc1 L_sl80
  s_branch L_sl80_b
L_sl81:
  s_xor_b32 s56, s49, 49152
  buffer_load_dwordx4 v[192:195], v14, s[24:27], s56 offen offset:0 sc1
  buffer_load_dwordx4 v[196:199], v14, s[24:27], s56 offen offset:2048 sc1
  s_waitcnt vmcnt(0)
  v_lshl_add_u64 v[192:193], v[192:193], 0, v[28:29]
  v_lshl_add_u64 v[196:197], v[196:197], 0, v[28:29]
  v_or3_b32 v15, v192, v193, v196
  v_bitop3_b32 v15, v15, v197, s81 bitop3:0xa8
  v_cmp_ne_u32 vcc, 0, v15
  s_cbranch_vccz L_sl81_b
  s_add_u32 s43, s43, 1
  s_cmp_lt_u32 s43, 30000
  s_cbranch_scc1 L_sl81
  s_branch L_sl81_b
L_sl82:
  s_xor_b32 s56, s49, 53248
  buffer_load_dwordx4 v[200:203], v14, s[24:27], s56 offen offset:0 sc1
  buffer_load_dwordx4 v[204:207], v14, s[24:27], s56 offen offset:2048 sc1
  s_waitcnt vmcnt(0)
  v_lshl_add_u64 v[200:201], v[200:201], 0, v[28:29]
  v_lshl_add_u64 v[204:205], v[204:205], 0, v[28:29]
  v_or3_b32 v15, v200, v201, v204
  v_bitop3_b32 v15, v15, v205, s81 bitop3:0xa8
  v_cmp_ne_u32 vcc, 0, v15
  s_cbranch_vccz L_sl82_b
  s_add_u32 s43, s43, 1
  s_cmp_lt_u32 s43, 30000
  s_cbranch_scc1 L_sl82
  s_branch L_sl82_b
L_end:
  s_endpgm
.section .rodata,"a"
.p2align 6
.amdhsa_kernel sequential_preLN__sliding_local_dilated__mixer_token_mlp__prompt_kernel
  .amdhsa_next_free_vgpr 512
  .amdhsa_next_free_sgpr 102
  .amdhsa_accum_offset 256
  .amdhsa_group_segment_fixed_size 0
  .amdhsa_kernarg_size 88
  .amdhsa_user_sgpr_count 2
  .amdhsa_user_sgpr_kernarg_segment_ptr 1
  .amdhsa_system_sgpr_workgroup_id_x 1
.end_amdhsa_kernel
```
